```python
import torch

def _softmax(x, axis=-1):
    return torch.softmax(x, dim=axis)
def _gelu(x):
    return torch.nn.functional.gelu(x, approximate="tanh")
def _silu(x):
    return torch.nn.functional.silu(x)
def _sigmoid(x):
    return torch.sigmoid(x)
def _layernorm(x, axis=-1, eps=1e-5):
    m = x.mean(dim=axis, keepdim=True)
    v = x.var(dim=axis, keepdim=True, unbiased=False)
    return (x - m) / torch.sqrt(v + eps)
def _scatter_add(tgt, idx, src, axis=0):
    return tgt.clone().index_add_(axis, idx, src)
def _segment_sum(src, seg, n):
    out = torch.zeros((n,) + src.shape[1:], dtype=src.dtype)
    return out.index_add_(0, seg, src)
def _pad(x, pw):
    flat = tuple(v for pair in reversed(pw) for v in pair)
    return torch.nn.functional.pad(x, flat)

kernel_name = 'standalone__batchnorm__sampling'

def setup_inputs():

    _w = (lambda a: (lambda t: t.to(torch.bfloat16) if t.is_floating_point() else t)(torch.as_tensor(a)))
    B, S, C = 1024, 8, 1024
    K = 3
    return {
        "x": _w((lambda *s: torch.randn(*s, dtype=torch.bfloat16) * 0.05)(B, S, C)),
        "w": _w((lambda *s: torch.randn(*s, dtype=torch.bfloat16) * 0.05)(K, C, C) * (1.0 / (K * C) ** 0.5)),
        "mean": _w((lambda *s: torch.randn(*s, dtype=torch.bfloat16) * 0.05)(C) * 0.1),
        "var": _w(torch.abs((lambda *s: torch.randn(*s, dtype=torch.bfloat16) * 0.05)(C)) + 0.5),
        "g": _w((lambda *s: torch.randn(*s, dtype=torch.bfloat16) * 0.05)(C) + 1.0),
        "b": _w((lambda *s: torch.randn(*s, dtype=torch.bfloat16) * 0.05)(C) * 0.1),
    }

def reference(x, w, mean, var, g, b):
    K = 3
    P = K // 2
    S = x.shape[1]
    xp = _pad(x, ((0, 0), (P, P), (0, 0)))
    y = sum(torch.einsum('bsc,cd->bsd', xp[:, k:k + S, :], w[k]) for k in range(K))
    inv_std = 1.0 / torch.sqrt(var + 1e-5)
    y = (y - mean) * (g * inv_std) + b
    return _silu(y)
```

```asm
; @launch grid=(256,1,1) block=(512,1,1) lds=163840
.amdgcn_target "amdgcn-amd-amdhsa--gfx950"
.text
.globl standalone__batchnorm__sampling_kernel
.p2align 12
.fill 640, 4, 0xbf810000
.p2align 8
.type standalone__batchnorm__sampling_kernel,@function
standalone__batchnorm__sampling_kernel:
    s_cmp_ge_u32 s2, 256
    s_cbranch_scc1 L_end
    s_load_dwordx4 s[4:7], s[0:1], 0
    s_load_dwordx8 s[44:51], s[0:1], 16
    s_load_dwordx2 s[52:53], s[0:1], 48
    v_lshrrev_b32 v12, 6, v0
    s_getpc_b64 s[64:65]
    s_and_b32 s64, s64, 0xffffff00
    v_xor_b32 v13, 256, v0
    v_lshlrev_b32 v13, 7, v13
    v_cmp_gt_u32 vcc, L_tail-standalone__batchnorm__sampling_kernel, v13
    s_and_saveexec_b64 s[66:67], vcc
    s_cbranch_execz L_nopf
    global_load_dword v10, v13, s[64:65]
L_nopf:
    s_mov_b64 exec, -1
    v_readfirstlane_b32 s24, v12
    v_and_b32 v0, 63, v0
    s_and_b32 s3, s2, 7
    s_lshr_b32 s40, s2, 3
    s_lshr_b32 s25, s3, 1
    s_lshl_b32 s25, s25, 3
    s_lshr_b32 s41, s40, 2
    s_add_u32 s25, s25, s41
    s_and_b32 s26, s3, 1
    s_lshl_b32 s26, s26, 2
    s_and_b32 s41, s40, 3
    s_add_u32 s26, s26, s41
    s_lshl_b32 s25, s25, 19
    s_lshl_b32 s26, s26, 8
    s_and_b32 s40, s24, 3
    s_cmp_lt_u32 s24, 4
    s_cbranch_scc1 L_consumer
    v_lshrrev_b32 v12, 4, v0
    s_and_b32 s42, s40, 1
    s_lshl_b32 s43, s42, 1
    v_lshl_add_u32 v13, v12, 2, s43
    v_xor_b32 v13, v13, v0
    v_and_b32 v13, 15, v13
    v_lshlrev_b32 v13, 4, v13
    v_lshl_add_u32 v2, v12, 11, v13
    s_lshl_b32 s41, s40, 14
    v_add_u32 v2, s41, v2
    s_lshl_b32 s43, s42, 2
    v_xor_b32 v13, v12, v0
    v_xor_b32 v13, s43, v13
    v_and_b32 v13, 7, v13
    v_lshlrev_b32 v13, 4, v13
    v_lshrrev_b32 v14, 3, v0
    v_lshl_add_u32 v1, v14, 14, v13
    s_lshr_b32 s43, s40, 1
    s_lshl_b32 s41, s42, 17
    s_lshl_b32 s27, s43, 11
    s_add_u32 s41, s41, s27
    v_add_u32 v1, s41, v1
    s_lshl_b32 s27, s43, 12
    s_lshl_b32 s41, s42, 10
    s_add_u32 s27, s27, s41
    s_mov_b32 s33, 7168
    s_mov_b32 s34, 2095104
    s_mov_b32 s35, 2102272
    s_mov_b32 s36, 4194304
    s_mov_b32 s37, 4201472
    s_mov_b32 s56, 4096
    s_mov_b32 s57, 8192
    s_mov_b32 s58, 12288
    s_mov_b32 s31, 262144
    s_mov_b32 s38, 266240
    s_mov_b32 s39, 270336
    s_mov_b32 s32, 274432
    s_mul_i32 s28, s40, 6144
    s_add_u32 s28, s28, 65536
    s_add_u32 s59, s28, 98304
    s_mov_b32 s11, 0x20000
    s_mov_b32 s15, 0x20000
    s_sub_u32 s10, 16777216, s25
    s_sub_u32 s14, 6291456, s26
    s_waitcnt lgkmcnt(0)
    s_add_u32 s12, s6, s26
    s_addc_u32 s13, s7, 0
    s_add_u32 s8, s4, s25
    s_addc_u32 s9, s5, 0
    s_mov_b32 m0, s28
    s_nop 0
    buffer_load_dwordx4 v2, s[12:15], 0 offen lds
    buffer_load_dwordx4 v2, s[12:15], s33 offen offset:1024 lds
    buffer_load_dwordx4 v2, s[12:15], s34 offen offset:2048 lds
    buffer_load_dwordx4 v2, s[12:15], s35 offen offset:3072 lds
    s_add_u32 m0, s28, 4096
    s_nop 0
    buffer_load_dwordx4 v2, s[12:15], s36 offen lds
    buffer_load_dwordx4 v2, s[12:15], s37 offen offset:1024 lds
    s_add_u32 s12, s12, 65536
    s_addc_u32 s13, s13, 0
    s_sub_u32 s14, s14, 65536
    s_add_u32 s28, s28, 24576
    s_cmp_eq_u32 s28, s59
    s_cselect_b32 s41, 98304, 0
    s_sub_u32 s28, s28, s41
    s_mov_b32 m0, s27
    s_nop 0
    buffer_load_dwordx4 v1, s[8:11], 0 offen nt lds
    s_add_u32 m0, s27, 8192
    s_nop 0
    buffer_load_dwordx4 v1, s[8:11], s56 offen nt lds
    s_add_u32 m0, s27, 16384
    s_nop 0
    buffer_load_dwordx4 v1, s[8:11], s57 offen nt lds
    s_add_u32 m0, s27, 24576
    s_nop 0
    buffer_load_dwordx4 v1, s[8:11], s58 offen nt lds
    s_add_u32 m0, s27, 2048
    s_nop 0
    buffer_load_dwordx4 v1, s[8:11], s31 offen nt lds
    s_add_u32 m0, s27, 10240
    s_nop 0
    buffer_load_dwordx4 v1, s[8:11], s38 offen nt lds
    s_add_u32 m0, s27, 18432
    s_nop 0
    buffer_load_dwordx4 v1, s[8:11], s39 offen nt lds
    s_add_u32 m0, s27, 26624
    s_nop 0
    buffer_load_dwordx4 v1, s[8:11], s32 offen nt lds
    s_add_u32 s8, s8, 128
    s_addc_u32 s9, s9, 0
    s_sub_u32 s10, s10, 128
    s_xor_b32 s27, s27, 32768
    s_mov_b32 m0, s28
    s_nop 0
    buffer_load_dwordx4 v2, s[12:15], 0 offen lds
    buffer_load_dwordx4 v2, s[12:15], s33 offen offset:1024 lds
    s_waitcnt vmcnt(7)
    s_barrier
    buffer_load_dwordx4 v2, s[12:15], s34 offen offset:2048 lds
    buffer_load_dwordx4 v2, s[12:15], s35 offen offset:3072 lds
    s_waitcnt vmcnt(7)
    s_barrier
    s_add_u32 m0, s28, 4096
    s_nop 0
    buffer_load_dwordx4 v2, s[12:15], s36 offen lds
    buffer_load_dwordx4 v2, s[12:15], s37 offen offset:1024 lds
    s_add_u32 s12, s12, 65536
    s_addc_u32 s13, s13, 0
    s_sub_u32 s14, s14, 65536
    s_add_u32 s28, s28, 24576
    s_cmp_eq_u32 s28, s59
    s_cselect_b32 s41, 98304, 0
    s_sub_u32 s28, s28, s41
    s_mov_b32 m0, s28
    s_nop 0
    buffer_load_dwordx4 v2, s[12:15], 0 offen lds
    s_waitcnt vmcnt(7)
    s_barrier
    buffer_load_dwordx4 v2, s[12:15], s33 offen offset:1024 lds
    buffer_load_dwordx4 v2, s[12:15], s34 offen offset:2048 lds
    buffer_load_dwordx4 v2, s[12:15], s35 offen offset:3072 lds
    s_add_u32 m0, s28, 4096
    s_nop 0
    buffer_load_dwordx4 v2, s[12:15], s36 offen lds
    buffer_load_dwordx4 v2, s[12:15], s37 offen offset:1024 lds
    s_add_u32 s12, s12, 65536
    s_addc_u32 s13, s13, 0
    s_sub_u32 s14, s14, 65536
    s_add_u32 s28, s28, 24576
    s_cmp_eq_u32 s28, s59
    s_cselect_b32 s41, 98304, 0
    s_sub_u32 s28, s28, s41
    s_mov_b32 m0, s27
    s_nop 0
    buffer_load_dwordx4 v1, s[8:11], 0 offen nt lds
    s_add_u32 m0, s27, 8192
    s_nop 0
    buffer_load_dwordx4 v1, s[8:11], s56 offen nt lds
    s_add_u32 m0, s27, 16384
    s_nop 0
    buffer_load_dwordx4 v1, s[8:11], s57 offen nt lds
    s_add_u32 m0, s27, 24576
    s_nop 0
    buffer_load_dwordx4 v1, s[8:11], s58 offen nt lds
    s_waitcnt vmcnt(10)
    s_barrier
    s_add_u32 m0, s27, 2048
    s_nop 0
    buffer_load_dwordx4 v1, s[8:11], s31 offen nt lds
    s_add_u32 m0, s27, 10240
    s_nop 0
    buffer_load_dwordx4 v1, s[8:11], s38 offen nt lds
    s_add_u32 m0, s27, 18432
    s_nop 0
    buffer_load_dwordx4 v1, s[8:11], s39 offen nt lds
    s_add_u32 m0, s27, 26624
    s_nop 0
    buffer_load_dwordx4 v1, s[8:11], s32 offen nt lds
    s_add_u32 s8, s8, 128
    s_addc_u32 s9, s9, 0
    s_sub_u32 s10, s10, 128
    s_xor_b32 s27, s27, 32768
    s_mov_b32 m0, s28
    s_nop 0
    buffer_load_dwordx4 v2, s[12:15], 0 offen lds
    buffer_load_dwordx4 v2, s[12:15], s33 offen offset:1024 lds
    buffer_load_dwordx4 v2, s[12:15], s34 offen offset:2048 lds
    buffer_load_dwordx4 v2, s[12:15], s35 offen offset:3072 lds
    s_add_u32 m0, s28, 4096
    s_nop 0
    buffer_load_dwordx4 v2, s[12:15], s36 offen lds
    buffer_load_dwordx4 v2, s[12:15], s37 offen offset:1024 lds
    s_add_u32 s12, s12, 65536
    s_addc_u32 s13, s13, 0
    s_sub_u32 s14, s14, 65536
    s_add_u32 s28, s28, 24576
    s_cmp_eq_u32 s28, s59
    s_cselect_b32 s41, 98304, 0
    s_sub_u32 s28, s28, s41
    s_lshl_b32 s41, s40, 11
    s_add_u32 s41, s41, (L_tail-standalone__batchnorm__sampling_kernel)&0xffffff80
    v_min_u32 v12, 15, v0
    v_lshl_add_u32 v3, v12, 7, s41
    v_min_u32 v3, (L_end-standalone__batchnorm__sampling_kernel)&0xffffffc0, v3
    s_mov_b32 m0, s28
    s_nop 0
    buffer_load_dwordx4 v2, s[12:15], 0 offen lds
    buffer_load_dwordx4 v2, s[12:15], s33 offen offset:1024 lds
    buffer_load_dwordx4 v2, s[12:15], s34 offen offset:2048 lds
    buffer_load_dwordx4 v2, s[12:15], s35 offen offset:3072 lds
    s_add_u32 m0, s28, 4096
    s_nop 0
    buffer_load_dwordx4 v2, s[12:15], s36 offen lds
    buffer_load_dwordx4 v2, s[12:15], s37 offen offset:1024 lds
    s_add_u32 s12, s12, 65536
    s_addc_u32 s13, s13, 0
    s_sub_u32 s14, s14, 65536
    s_add_u32 s28, s28, 24576
    s_cmp_eq_u32 s28, s59
    s_cselect_b32 s41, 98304, 0
    s_sub_u32 s28, s28, s41
    s_mov_b32 s30, 0
L_ld_loop:
    s_waitcnt vmcnt(12)
    s_barrier
    s_mov_b32 m0, s27
    s_nop 0
    buffer_load_dwordx4 v1, s[8:11], 0 offen nt lds
    s_add_u32 m0, s27, 8192
    s_nop 0
    buffer_load_dwordx4 v1, s[8:11], s56 offen nt lds
    s_add_u32 m0, s27, 16384
    s_nop 0
    buffer_load_dwordx4 v1, s[8:11], s57 offen nt lds
    s_add_u32 m0, s27, 24576
    s_nop 0
    buffer_load_dwordx4 v1, s[8:11], s58 offen nt lds
    s_add_u32 m0, s27, 2048
    s_nop 0
    buffer_load_dwordx4 v1, s[8:11], s31 offen nt lds
    s_add_u32 m0, s27, 10240
    s_nop 0
    buffer_load_dwordx4 v1, s[8:11], s38 offen nt lds
    s_add_u32 m0, s27, 18432
    s_nop 0
    buffer_load_dwordx4 v1, s[8:11], s39 offen nt lds
    s_add_u32 m0, s27, 26624
    s_nop 0
    buffer_load_dwordx4 v1, s[8:11], s32 offen nt lds
    s_add_u32 s8, s8, 128
    s_addc_u32 s9, s9, 0
    s_sub_u32 s10, s10, 128
    s_xor_b32 s27, s27, 32768
    s_add_u32 s30, s30, 2
    s_cmp_ge_u32 s30, 28
    s_cbranch_scc1 L_ld_last
    s_waitcnt vmcnt(14)
    s_barrier
    s_mov_b32 m0, s28
    s_nop 0
    buffer_load_dwordx4 v2, s[12:15], 0 offen lds
    buffer_load_dwordx4 v2, s[12:15], s33 offen offset:1024 lds
    buffer_load_dwordx4 v2, s[12:15], s34 offen offset:2048 lds
    buffer_load_dwordx4 v2, s[12:15], s35 offen offset:3072 lds
    s_add_u32 m0, s28, 4096
    s_nop 0
    buffer_load_dwordx4 v2, s[12:15], s36 offen lds
    buffer_load_dwordx4 v2, s[12:15], s37 offen offset:1024 lds
    s_add_u32 s12, s12, 65536
    s_addc_u32 s13, s13, 0
    s_sub_u32 s14, s14, 65536
    s_add_u32 s28, s28, 24576
    s_cmp_eq_u32 s28, s59
    s_cselect_b32 s41, 98304, 0
    s_sub_u32 s28, s28, s41
    s_mov_b32 m0, s28
    s_nop 0
    buffer_load_dwordx4 v2, s[12:15], 0 offen lds
    buffer_load_dwordx4 v2, s[12:15], s33 offen offset:1024 lds
    buffer_load_dwordx4 v2, s[12:15], s34 offen offset:2048 lds
    buffer_load_dwordx4 v2, s[12:15], s35 offen offset:3072 lds
    s_add_u32 m0, s28, 4096
    s_nop 0
    buffer_load_dwordx4 v2, s[12:15], s36 offen lds
    buffer_load_dwordx4 v2, s[12:15], s37 offen offset:1024 lds
    s_add_u32 s12, s12, 65536
    s_addc_u32 s13, s13, 0
    s_sub_u32 s14, s14, 65536
    s_add_u32 s28, s28, 24576
    s_cmp_eq_u32 s28, s59
    s_cselect_b32 s41, 98304, 0
    s_sub_u32 s28, s28, s41
    s_cmp_lg_u32 s30, 22
    s_cbranch_scc1 L_noct
    global_load_dword v4, v3, s[64:65]
L_noct:
    s_branch L_ld_loop
L_ld_last:
    s_mov_b32 m0, s28
    s_nop 0
    buffer_load_dwordx4 v2, s[12:15], 0 offen lds
    buffer_load_dwordx4 v2, s[12:15], s33 offen offset:1024 lds
    buffer_load_dwordx4 v2, s[12:15], s34 offen offset:2048 lds
    buffer_load_dwordx4 v2, s[12:15], s35 offen offset:3072 lds
    s_add_u32 m0, s28, 4096
    s_nop 0
    buffer_load_dwordx4 v2, s[12:15], s36 offen lds
    buffer_load_dwordx4 v2, s[12:15], s37 offen offset:1024 lds
    s_add_u32 s12, s12, 65536
    s_addc_u32 s13, s13, 0
    s_sub_u32 s14, s14, 65536
    s_add_u32 s28, s28, 24576
    s_cmp_eq_u32 s28, s59
    s_cselect_b32 s41, 98304, 0
    s_sub_u32 s28, s28, s41
    s_waitcnt vmcnt(14)
    s_barrier
    s_waitcnt vmcnt(0)
    s_barrier
    s_endpgm
L_consumer:
    s_mov_b32 s22, 2048
    s_mov_b32 s23, 0x20000
    s_mov_b32 s19, 0x20000
    v_lshrrev_b32 v14, 4, v0
    s_lshl_b32 s41, s40, 6
    s_add_u32 s41, s41, s26
    v_lshl_add_u32 v12, v14, 3, s41
    v_bfe_u32 v13, v0, 2, 1
    v_lshl_add_u32 v12, v13, 5, v12
    v_and_b32 v13, 3, v0
    v_lshl_add_u32 v36, v13, 1, v12
    v_and_b32 v12, 15, v0
    v_lshrrev_b32 v13, 1, v12
    v_xor_b32 v13, v13, v14
    v_lshlrev_b32 v13, 4, v13
    v_lshl_add_u32 v6, v12, 7, v13
    v_xor_b32 v7, 64, v6
    v_lshlrev_b32 v12, 14, v12
    v_bfe_u32 v13, v0, 4, 1
    v_lshl_add_u32 v12, v13, 5, v12
    v_lshrrev_b32 v13, 5, v0
    v_lshl_add_u32 v12, v13, 4, v12
    s_lshl_b32 s41, s40, 6
    v_add_u32 v11, s41, v12
    v_bfe_u32 v12, v0, 2, 2
    v_xor_b32 v13, s40, v12
    v_lshlrev_b32 v13, 6, v13
    v_lshl_add_u32 v13, v12, 8, v13
    v_mul_u32_u24 v15, 6144, v14
    v_add_u32 v13, v13, v15
    v_and_b32 v14, 1, v14
    v_lshl_add_u32 v13, v14, 5, v13
    v_and_b32 v14, 3, v0
    v_lshl_add_u32 v13, v14, 3, v13
    v_add_u32 v8, 65536, v13
    v_xor_b32 v9, 32, v8
    s_mov_b32 s38, 0xbfb8aa3b
    s_mov_b32 s39, 0xbfb8aa3b
    s_mov_b32 s29, 49152
    s_mov_b32 s30, 0
    v_mov_b64 v[128:129], 0
    v_mov_b64 v[130:131], 0
    v_mov_b64 v[132:133], 0
    v_mov_b64 v[134:135], 0
    v_mov_b64 v[136:137], 0
    v_mov_b64 v[138:139], 0
    v_mov_b64 v[140:141], 0
    v_mov_b64 v[142:143], 0
    v_mov_b64 v[144:145], 0
    v_mov_b64 v[146:147], 0
    v_mov_b64 v[148:149], 0
    v_mov_b64 v[150:151], 0
    v_mov_b64 v[152:153], 0
    v_mov_b64 v[154:155], 0
    v_mov_b64 v[156:157], 0
    v_mov_b64 v[158:159], 0
    v_mov_b64 v[160:161], 0
    v_mov_b64 v[162:163], 0
    v_mov_b64 v[164:165], 0
    v_mov_b64 v[166:167], 0
    v_mov_b64 v[168:169], 0
    v_mov_b64 v[170:171], 0
    v_mov_b64 v[172:173], 0
    v_mov_b64 v[174:175], 0
    v_mov_b64 v[176:177], 0
    v_mov_b64 v[178:179], 0
    v_mov_b64 v[180:181], 0
    v_mov_b64 v[182:183], 0
    v_mov_b64 v[184:185], 0
    v_mov_b64 v[186:187], 0
    v_mov_b64 v[188:189], 0
    v_mov_b64 v[190:191], 0
    v_mov_b64 v[192:193], 0
    v_mov_b64 v[194:195], 0
    v_mov_b64 v[196:197], 0
    v_mov_b64 v[198:199], 0
    v_mov_b64 v[200:201], 0
    v_mov_b64 v[202:203], 0
    v_mov_b64 v[204:205], 0
    v_mov_b64 v[206:207], 0
    v_mov_b64 v[208:209], 0
    v_mov_b64 v[210:211], 0
    v_mov_b64 v[212:213], 0
    v_mov_b64 v[214:215], 0
    v_mov_b64 v[216:217], 0
    v_mov_b64 v[218:219], 0
    v_mov_b64 v[220:221], 0
    v_mov_b64 v[222:223], 0
    v_mov_b64 v[224:225], 0
    v_mov_b64 v[226:227], 0
    v_mov_b64 v[228:229], 0
    v_mov_b64 v[230:231], 0
    v_mov_b64 v[232:233], 0
    v_mov_b64 v[234:235], 0
    v_mov_b64 v[236:237], 0
    v_mov_b64 v[238:239], 0
    v_mov_b64 v[240:241], 0
    v_mov_b64 v[242:243], 0
    v_mov_b64 v[244:245], 0
    v_mov_b64 v[246:247], 0
    v_mov_b64 v[248:249], 0
    v_mov_b64 v[250:251], 0
    v_mov_b64 v[252:253], 0
    v_mov_b64 v[254:255], 0
    s_waitcnt lgkmcnt(0)
    s_add_u32 s41, s25, s26
    s_add_u32 s16, s52, s41
    s_addc_u32 s17, s53, 0
    s_sub_u32 s18, 16777216, s41
    s_barrier
    ds_read_b64_tr_b16 v[88:89], v8 offset:2048
    ds_read_b64_tr_b16 v[90:91], v8 offset:3072
    ds_read_b64_tr_b16 v[96:97], v8 offset:4096
    ds_read_b64_tr_b16 v[98:99], v8 offset:5120
    ds_read_b128 v[48:51], v6 offset:0
    ds_read_b128 v[52:55], v6 offset:4096
    ds_read_b64_tr_b16 v[92:93], v9 offset:2048
    ds_read_b64_tr_b16 v[94:95], v9 offset:3072
    ds_read_b64_tr_b16 v[100:101], v9 offset:4096
    ds_read_b64_tr_b16 v[102:103], v9 offset:5120
    ds_read_b64_tr_b16 v[80:81], v8 offset:0
    ds_read_b64_tr_b16 v[82:83], v8 offset:1024
    ds_read_b64_tr_b16 v[84:85], v9 offset:0
    ds_read_b64_tr_b16 v[86:87], v9 offset:1024
    ds_read_b128 v[56:59], v6 offset:8192
    ds_read_b128 v[60:63], v6 offset:12288
    ds_read_b128 v[64:67], v6 offset:16384
    ds_read_b128 v[68:71], v6 offset:20480
    s_waitcnt lgkmcnt(13)
    v_mfma_f32_16x16x32_bf16 v[128:131], v[88:91], v[48:51], v[128:131]
    s_waitcnt lgkmcnt(12)
    v_mfma_f32_16x16x32_bf16 v[128:131], v[96:99], v[52:55], v[128:131]
    s_waitcnt lgkmcnt(8)
    v_mfma_f32_16x16x32_bf16 v[132:135], v[100:103], v[52:55], v[132:135]
    s_barrier
    ds_read_b128 v[72:75], v6 offset:24576
    v_mfma_f32_16x16x32_bf16 v[132:135], v[92:95], v[48:51], v[132:135]
    s_waitcnt lgkmcnt(5)
    v_mfma_f32_16x16x32_bf16 v[148:151], v[84:87], v[48:51], v[148:151]
    ds_read_b128 v[76:79], v6 offset:28672
    v_mfma_f32_16x16x32_bf16 v[148:151], v[92:95], v[52:55], v[148:151]
    s_waitcnt lgkmcnt(5)
    v_mfma_f32_16x16x32_bf16 v[148:151], v[100:103], v[56:59], v[148:151]
    v_mfma_f32_16x16x32_bf16 v[144:147], v[96:99], v[56:59], v[144:147]
    v_mfma_f32_16x16x32_bf16 v[144:147], v[88:91], v[52:55], v[144:147]
    v_mfma_f32_16x16x32_bf16 v[144:147], v[80:83], v[48:51], v[144:147]
    v_mfma_f32_16x16x32_bf16 v[160:163], v[80:83], v[52:55], v[160:163]
    ds_read_b128 v[48:51], v6 offset:2048
    v_mfma_f32_16x16x32_bf16 v[160:163], v[88:91], v[56:59], v[160:163]
    s_waitcnt lgkmcnt(5)
    v_mfma_f32_16x16x32_bf16 v[160:163], v[96:99], v[60:63], v[160:163]
    v_mfma_f32_16x16x32_bf16 v[164:167], v[100:103], v[60:63], v[164:167]
    v_mfma_f32_16x16x32_bf16 v[164:167], v[92:95], v[56:59], v[164:167]
    v_mfma_f32_16x16x32_bf16 v[164:167], v[84:87], v[52:55], v[164:167]
    v_mfma_f32_16x16x32_bf16 v[180:183], v[84:87], v[56:59], v[180:183]
    ds_read_b128 v[52:55], v6 offset:6144
    v_mfma_f32_16x16x32_bf16 v[180:183], v[92:95], v[60:63], v[180:183]
    s_waitcnt lgkmcnt(5)
    v_mfma_f32_16x16x32_bf16 v[180:183], v[100:103], v[64:67], v[180:183]
    v_mfma_f32_16x16x32_bf16 v[176:179], v[96:99], v[64:67], v[176:179]
    v_mfma_f32_16x16x32_bf16 v[176:179], v[88:91], v[60:63], v[176:179]
    v_mfma_f32_16x16x32_bf16 v[176:179], v[80:83], v[56:59], v[176:179]
    v_mfma_f32_16x16x32_bf16 v[192:195], v[80:83], v[60:63], v[192:195]
    s_barrier
    ds_read_b128 v[56:59], v6 offset:10240
    v_mfma_f32_16x16x32_bf16 v[192:195], v[88:91], v[64:67], v[192:195]
    s_waitcnt lgkmcnt(5)
    v_mfma_f32_16x16x32_bf16 v[192:195], v[96:99], v[68:71], v[192:195]
    v_mfma_f32_16x16x32_bf16 v[196:199], v[100:103], v[68:71], v[196:199]
    v_mfma_f32_16x16x32_bf16 v[196:199], v[92:95], v[64:67], v[196:199]
    v_mfma_f32_16x16x32_bf16 v[196:199], v[84:87], v[60:63], v[196:199]
    v_mfma_f32_16x16x32_bf16 v[212:215], v[84:87], v[64:67], v[212:215]
    ds_read_b128 v[60:63], v6 offset:14336
    v_mfma_f32_16x16x32_bf16 v[212:215], v[92:95], v[68:71], v[212:215]
    s_waitcnt lgkmcnt(5)
    v_mfma_f32_16x16x32_bf16 v[212:215], v[100:103], v[72:75], v[212:215]
    v_mfma_f32_16x16x32_bf16 v[208:211], v[96:99], v[72:75], v[208:211]
    v_mfma_f32_16x16x32_bf16 v[208:211], v[88:91], v[68:71], v[208:211]
    v_mfma_f32_16x16x32_bf16 v[208:211], v[80:83], v[64:67], v[208:211]
    v_mfma_f32_16x16x32_bf16 v[224:227], v[80:83], v[68:71], v[224:227]
    ds_read_b128 v[64:67], v6 offset:18432
    v_mfma_f32_16x16x32_bf16 v[224:227], v[88:91], v[72:75], v[224:227]
    s_waitcnt lgkmcnt(5)
    v_mfma_f32_16x16x32_bf16 v[224:227], v[96:99], v[76:79], v[224:227]
    v_mfma_f32_16x16x32_bf16 v[228:231], v[100:103], v[76:79], v[228:231]
    v_mfma_f32_16x16x32_bf16 v[228:231], v[92:95], v[72:75], v[228:231]
    v_mfma_f32_16x16x32_bf16 v[228:231], v[84:87], v[68:71], v[228:231]
    v_mfma_f32_16x16x32_bf16 v[244:247], v[84:87], v[72:75], v[244:247]
    ds_read_b128 v[68:71], v6 offset:22528
    s_mov_b32 s20, s44
    s_mov_b32 s21, s45
    buffer_load_ushort v32, v36, s[20:23], 0 offen
    v_mfma_f32_16x16x32_bf16 v[244:247], v[92:95], v[76:79], v[244:247]
    v_mfma_f32_16x16x32_bf16 v[240:243], v[88:91], v[76:79], v[240:243]
    v_mfma_f32_16x16x32_bf16 v[240:243], v[80:83], v[72:75], v[240:243]
    s_waitcnt lgkmcnt(5)
    v_mfma_f32_16x16x32_bf16 v[136:139], v[88:91], v[48:51], v[136:139]
    ds_read_b128 v[72:75], v6 offset:26624
    s_waitcnt lgkmcnt(5)
    v_mfma_f32_16x16x32_bf16 v[136:139], v[96:99], v[52:55], v[136:139]
    v_mfma_f32_16x16x32_bf16 v[140:143], v[100:103], v[52:55], v[140:143]
    s_mov_b32 s20, s46
    s_mov_b32 s21, s47
    buffer_load_ushort v33, v36, s[20:23], 0 offen
    v_mfma_f32_16x16x32_bf16 v[140:143], v[92:95], v[48:51], v[140:143]
    v_mfma_f32_16x16x32_bf16 v[156:159], v[84:87], v[48:51], v[156:159]
    ds_read_b128 v[76:79], v6 offset:30720
    v_mfma_f32_16x16x32_bf16 v[156:159], v[92:95], v[52:55], v[156:159]
    v_xor_b32 v6, 32768, v6
    s_waitcnt lgkmcnt(5)
    v_mfma_f32_16x16x32_bf16 v[156:159], v[100:103], v[56:59], v[156:159]
    v_mfma_f32_16x16x32_bf16 v[152:155], v[96:99], v[56:59], v[152:155]
    v_mfma_f32_16x16x32_bf16 v[152:155], v[88:91], v[52:55], v[152:155]
    s_mov_b32 s20, s48
    s_mov_b32 s21, s49
    buffer_load_ushort v34, v36, s[20:23], 0 offen
    v_mfma_f32_16x16x32_bf16 v[152:155], v[80:83], v[48:51], v[152:155]
    v_mfma_f32_16x16x32_bf16 v[168:171], v[80:83], v[52:55], v[168:171]
    v_mfma_f32_16x16x32_bf16 v[168:171], v[88:91], v[56:59], v[168:171]
    s_waitcnt lgkmcnt(4)
    v_mfma_f32_16x16x32_bf16 v[168:171], v[96:99], v[60:63], v[168:171]
    v_mfma_f32_16x16x32_bf16 v[172:175], v[100:103], v[60:63], v[172:175]
    v_mfma_f32_16x16x32_bf16 v[172:175], v[92:95], v[56:59], v[172:175]
    s_waitcnt lgkmcnt(0)
    s_mov_b32 s20, s50
    s_mov_b32 s21, s51
    buffer_load_ushort v35, v36, s[20:23], 0 offen
    v_mfma_f32_16x16x32_bf16 v[172:175], v[84:87], v[52:55], v[172:175]
    s_barrier
    v_mfma_f32_16x16x32_bf16 v[188:191], v[84:87], v[56:59], v[188:191]
    ds_read_b128 v[48:51], v7 offset:0
    v_mfma_f32_16x16x32_bf16 v[188:191], v[92:95], v[60:63], v[188:191]
    ds_read_b128 v[52:55], v7 offset:4096
    v_mfma_f32_16x16x32_bf16 v[188:191], v[100:103], v[64:67], v[188:191]
    ds_read_b64_tr_b16 v[112:113], v8 offset:26624
    v_mfma_f32_16x16x32_bf16 v[184:187], v[96:99], v[64:67], v[184:187]
    ds_read_b64_tr_b16 v[114:115], v8 offset:27648
    v_mfma_f32_16x16x32_bf16 v[184:187], v[88:91], v[60:63], v[184:187]
    ds_read_b64_tr_b16 v[120:121], v8 offset:28672
    v_mfma_f32_16x16x32_bf16 v[184:187], v[80:83], v[56:59], v[184:187]
    ds_read_b64_tr_b16 v[122:123], v8 offset:29696
    v_mfma_f32_16x16x32_bf16 v[200:203], v[80:83], v[60:63], v[200:203]
    ds_read_b128 v[56:59], v7 offset:8192
    v_mfma_f32_16x16x32_bf16 v[200:203], v[88:91], v[64:67], v[200:203]
    ds_read_b64_tr_b16 v[116:117], v9 offset:26624
    v_mfma_f32_16x16x32_bf16 v[200:203], v[96:99], v[68:71], v[200:203]
    ds_read_b64_tr_b16 v[118:119], v9 offset:27648
    v_mfma_f32_16x16x32_bf16 v[204:207], v[100:103], v[68:71], v[204:207]
    ds_read_b64_tr_b16 v[124:125], v9 offset:28672
    v_mfma_f32_16x16x32_bf16 v[204:207], v[92:95], v[64:67], v[204:207]
    ds_read_b64_tr_b16 v[126:127], v9 offset:29696
    v_mfma_f32_16x16x32_bf16 v[204:207], v[84:87], v[60:63], v[204:207]
    ds_read_b64_tr_b16 v[104:105], v8 offset:24576
    v_mfma_f32_16x16x32_bf16 v[220:223], v[84:87], v[64:67], v[220:223]
    ds_read_b128 v[60:63], v7 offset:12288
    v_mfma_f32_16x16x32_bf16 v[220:223], v[92:95], v[68:71], v[220:223]
    ds_read_b64_tr_b16 v[106:107], v8 offset:25600
    v_mfma_f32_16x16x32_bf16 v[220:223], v[100:103], v[72:75], v[220:223]
    ds_read_b64_tr_b16 v[108:109], v9 offset:24576
    v_mfma_f32_16x16x32_bf16 v[216:219], v[96:99], v[72:75], v[216:219]
    ds_read_b64_tr_b16 v[110:111], v9 offset:25600
    v_mfma_f32_16x16x32_bf16 v[216:219], v[88:91], v[68:71], v[216:219]
    v_mfma_f32_16x16x32_bf16 v[216:219], v[80:83], v[64:67], v[216:219]
    v_mfma_f32_16x16x32_bf16 v[232:235], v[80:83], v[68:71], v[232:235]
    ds_read_b128 v[64:67], v7 offset:16384
    v_mfma_f32_16x16x32_bf16 v[232:235], v[88:91], v[72:75], v[232:235]
    v_mfma_f32_16x16x32_bf16 v[232:235], v[96:99], v[76:79], v[232:235]
    v_mfma_f32_16x16x32_bf16 v[236:239], v[100:103], v[76:79], v[236:239]
    v_mfma_f32_16x16x32_bf16 v[236:239], v[92:95], v[72:75], v[236:239]
    v_mfma_f32_16x16x32_bf16 v[236:239], v[84:87], v[68:71], v[236:239]
    v_mfma_f32_16x16x32_bf16 v[252:255], v[84:87], v[72:75], v[252:255]
    ds_read_b128 v[68:71], v7 offset:20480
    v_mfma_f32_16x16x32_bf16 v[252:255], v[92:95], v[76:79], v[252:255]
    v_mfma_f32_16x16x32_bf16 v[248:251], v[88:91], v[76:79], v[248:251]
    v_mfma_f32_16x16x32_bf16 v[248:251], v[80:83], v[72:75], v[248:251]
.p2align 6
L_loop:
    s_waitcnt lgkmcnt(14)
    v_mfma_f32_16x16x32_bf16 v[128:131], v[112:115], v[48:51], v[128:131]
    ds_read_b128 v[72:75], v7 offset:24576
    s_waitcnt lgkmcnt(13)
    v_mfma_f32_16x16x32_bf16 v[128:131], v[120:123], v[52:55], v[128:131]
    v_add_u32 v8, s29, v8
    s_waitcnt lgkmcnt(8)
    v_mfma_f32_16x16x32_bf16 v[132:135], v[124:127], v[52:55], v[132:135]
    v_add_u32 v9, s29, v9
    v_mfma_f32_16x16x32_bf16 v[132:135], v[116:119], v[48:51], v[132:135]
    s_sub_u32 s29, 0, s29
    s_waitcnt lgkmcnt(3)
    v_mfma_f32_16x16x32_bf16 v[148:151], v[108:111], v[48:51], v[148:151]
    ds_read_b128 v[76:79], v7 offset:28672
    v_mfma_f32_16x16x32_bf16 v[148:151], v[116:119], v[52:55], v[148:151]
    v_mfma_f32_16x16x32_bf16 v[148:151], v[124:127], v[56:59], v[148:151]
    v_mfma_f32_16x16x32_bf16 v[144:147], v[120:123], v[56:59], v[144:147]
    v_mfma_f32_16x16x32_bf16 v[144:147], v[112:115], v[52:55], v[144:147]
    v_mfma_f32_16x16x32_bf16 v[144:147], v[104:107], v[48:51], v[144:147]
    v_mfma_f32_16x16x32_bf16 v[160:163], v[104:107], v[52:55], v[160:163]
    ds_read_b128 v[48:51], v7 offset:2048
    v_mfma_f32_16x16x32_bf16 v[160:163], v[112:115], v[56:59], v[160:163]
    v_mfma_f32_16x16x32_bf16 v[160:163], v[120:123], v[60:63], v[160:163]
    v_mfma_f32_16x16x32_bf16 v[164:167], v[124:127], v[60:63], v[164:167]
    v_mfma_f32_16x16x32_bf16 v[164:167], v[116:119], v[56:59], v[164:167]
    v_mfma_f32_16x16x32_bf16 v[164:167], v[108:111], v[52:55], v[164:167]
    v_mfma_f32_16x16x32_bf16 v[180:183], v[108:111], v[56:59], v[180:183]
    ds_read_b128 v[52:55], v7 offset:6144
    v_mfma_f32_16x16x32_bf16 v[180:183], v[116:119], v[60:63], v[180:183]
    s_waitcnt lgkmcnt(5)
    v_mfma_f32_16x16x32_bf16 v[180:183], v[124:127], v[64:67], v[180:183]
    v_mfma_f32_16x16x32_bf16 v[176:179], v[120:123], v[64:67], v[176:179]
    v_mfma_f32_16x16x32_bf16 v[176:179], v[112:115], v[60:63], v[176:179]
    v_mfma_f32_16x16x32_bf16 v[176:179], v[104:107], v[56:59], v[176:179]
    v_mfma_f32_16x16x32_bf16 v[192:195], v[104:107], v[60:63], v[192:195]
    ds_read_b128 v[56:59], v7 offset:10240
    v_mfma_f32_16x16x32_bf16 v[192:195], v[112:115], v[64:67], v[192:195]
    s_waitcnt lgkmcnt(5)
    v_mfma_f32_16x16x32_bf16 v[192:195], v[120:123], v[68:71], v[192:195]
    v_mfma_f32_16x16x32_bf16 v[196:199], v[124:127], v[68:71], v[196:199]
    v_mfma_f32_16x16x32_bf16 v[196:199], v[116:119], v[64:67], v[196:199]
    v_mfma_f32_16x16x32_bf16 v[196:199], v[108:111], v[60:63], v[196:199]
    v_mfma_f32_16x16x32_bf16 v[212:215], v[108:111], v[64:67], v[212:215]
    ds_read_b128 v[60:63], v7 offset:14336
    v_mfma_f32_16x16x32_bf16 v[212:215], v[116:119], v[68:71], v[212:215]
    s_waitcnt lgkmcnt(5)
    v_mfma_f32_16x16x32_bf16 v[212:215], v[124:127], v[72:75], v[212:215]
    v_mfma_f32_16x16x32_bf16 v[208:211], v[120:123], v[72:75], v[208:211]
    v_mfma_f32_16x16x32_bf16 v[208:211], v[112:115], v[68:71], v[208:211]
    v_mfma_f32_16x16x32_bf16 v[208:211], v[104:107], v[64:67], v[208:211]
    v_mfma_f32_16x16x32_bf16 v[224:227], v[104:107], v[68:71], v[224:227]
    ds_read_b128 v[64:67], v7 offset:18432
    v_mfma_f32_16x16x32_bf16 v[224:227], v[112:115], v[72:75], v[224:227]
    s_waitcnt lgkmcnt(5)
    v_mfma_f32_16x16x32_bf16 v[224:227], v[120:123], v[76:79], v[224:227]
    v_mfma_f32_16x16x32_bf16 v[228:231], v[124:127], v[76:79], v[228:231]
    v_mfma_f32_16x16x32_bf16 v[228:231], v[116:119], v[72:75], v[228:231]
    v_mfma_f32_16x16x32_bf16 v[228:231], v[108:111], v[68:71], v[228:231]
    v_mfma_f32_16x16x32_bf16 v[244:247], v[108:111], v[72:75], v[244:247]
    ds_read_b128 v[68:71], v7 offset:22528
    v_mfma_f32_16x16x32_bf16 v[244:247], v[116:119], v[76:79], v[244:247]
    v_mfma_f32_16x16x32_bf16 v[240:243], v[112:115], v[76:79], v[240:243]
    v_mfma_f32_16x16x32_bf16 v[240:243], v[104:107], v[72:75], v[240:243]
    s_waitcnt lgkmcnt(5)
    v_mfma_f32_16x16x32_bf16 v[136:139], v[112:115], v[48:51], v[136:139]
    ds_read_b128 v[72:75], v7 offset:26624
    s_waitcnt lgkmcnt(5)
    v_mfma_f32_16x16x32_bf16 v[136:139], v[120:123], v[52:55], v[136:139]
    v_mfma_f32_16x16x32_bf16 v[140:143], v[124:127], v[52:55], v[140:143]
    v_mfma_f32_16x16x32_bf16 v[140:143], v[116:119], v[48:51], v[140:143]
    v_mfma_f32_16x16x32_bf16 v[156:159], v[108:111], v[48:51], v[156:159]
    ds_read_b128 v[76:79], v7 offset:30720
    v_mfma_f32_16x16x32_bf16 v[156:159], v[116:119], v[52:55], v[156:159]
    v_xor_b32 v7, 32768, v7
    s_waitcnt lgkmcnt(5)
    v_mfma_f32_16x16x32_bf16 v[156:159], v[124:127], v[56:59], v[156:159]
    v_mfma_f32_16x16x32_bf16 v[152:155], v[120:123], v[56:59], v[152:155]
    v_mfma_f32_16x16x32_bf16 v[152:155], v[112:115], v[52:55], v[152:155]
    v_mfma_f32_16x16x32_bf16 v[152:155], v[104:107], v[48:51], v[152:155]
    v_mfma_f32_16x16x32_bf16 v[168:171], v[104:107], v[52:55], v[168:171]
    v_mfma_f32_16x16x32_bf16 v[168:171], v[112:115], v[56:59], v[168:171]
    s_waitcnt lgkmcnt(4)
    v_mfma_f32_16x16x32_bf16 v[168:171], v[120:123], v[60:63], v[168:171]
    v_mfma_f32_16x16x32_bf16 v[172:175], v[124:127], v[60:63], v[172:175]
    v_mfma_f32_16x16x32_bf16 v[172:175], v[116:119], v[56:59], v[172:175]
    s_waitcnt lgkmcnt(0)
    v_mfma_f32_16x16x32_bf16 v[172:175], v[108:111], v[52:55], v[172:175]
    s_barrier
    v_mfma_f32_16x16x32_bf16 v[188:191], v[108:111], v[56:59], v[188:191]
    ds_read_b128 v[48:51], v6 offset:0
    v_mfma_f32_16x16x32_bf16 v[188:191], v[116:119], v[60:63], v[188:191]
    ds_read_b128 v[52:55], v6 offset:4096
    v_mfma_f32_16x16x32_bf16 v[188:191], v[124:127], v[64:67], v[188:191]
    ds_read_b64_tr_b16 v[88:89], v8 offset:2048
    v_mfma_f32_16x16x32_bf16 v[184:187], v[120:123], v[64:67], v[184:187]
    ds_read_b64_tr_b16 v[90:91], v8 offset:3072
    v_mfma_f32_16x16x32_bf16 v[184:187], v[112:115], v[60:63], v[184:187]
    ds_read_b64_tr_b16 v[96:97], v8 offset:4096
    v_mfma_f32_16x16x32_bf16 v[184:187], v[104:107], v[56:59], v[184:187]
    ds_read_b64_tr_b16 v[98:99], v8 offset:5120
    v_mfma_f32_16x16x32_bf16 v[200:203], v[104:107], v[60:63], v[200:203]
    ds_read_b128 v[56:59], v6 offset:8192
    v_mfma_f32_16x16x32_bf16 v[200:203], v[112:115], v[64:67], v[200:203]
    ds_read_b64_tr_b16 v[92:93], v9 offset:2048
    v_mfma_f32_16x16x32_bf16 v[200:203], v[120:123], v[68:71], v[200:203]
    ds_read_b64_tr_b16 v[94:95], v9 offset:3072
    v_mfma_f32_16x16x32_bf16 v[204:207], v[124:127], v[68:71], v[204:207]
    ds_read_b64_tr_b16 v[100:101], v9 offset:4096
    v_mfma_f32_16x16x32_bf16 v[204:207], v[116:119], v[64:67], v[204:207]
    ds_read_b64_tr_b16 v[102:103], v9 offset:5120
    v_mfma_f32_16x16x32_bf16 v[204:207], v[108:111], v[60:63], v[204:207]
    ds_read_b64_tr_b16 v[80:81], v8 offset:0
    v_mfma_f32_16x16x32_bf16 v[220:223], v[108:111], v[64:67], v[220:223]
    ds_read_b128 v[60:63], v6 offset:12288
    v_mfma_f32_16x16x32_bf16 v[220:223], v[116:119], v[68:71], v[220:223]
    ds_read_b64_tr_b16 v[82:83], v8 offset:1024
    v_mfma_f32_16x16x32_bf16 v[220:223], v[124:127], v[72:75], v[220:223]
    ds_read_b64_tr_b16 v[84:85], v9 offset:0
    v_mfma_f32_16x16x32_bf16 v[216:219], v[120:123], v[72:75], v[216:219]
    ds_read_b64_tr_b16 v[86:87], v9 offset:1024
    v_mfma_f32_16x16x32_bf16 v[216:219], v[112:115], v[68:71], v[216:219]
    v_mfma_f32_16x16x32_bf16 v[216:219], v[104:107], v[64:67], v[216:219]
    v_mfma_f32_16x16x32_bf16 v[232:235], v[104:107], v[68:71], v[232:235]
    ds_read_b128 v[64:67], v6 offset:16384
    v_mfma_f32_16x16x32_bf16 v[232:235], v[112:115], v[72:75], v[232:235]
    v_mfma_f32_16x16x32_bf16 v[232:235], v[120:123], v[76:79], v[232:235]
    v_mfma_f32_16x16x32_bf16 v[236:239], v[124:127], v[76:79], v[236:239]
    v_mfma_f32_16x16x32_bf16 v[236:239], v[116:119], v[72:75], v[236:239]
    v_mfma_f32_16x16x32_bf16 v[236:239], v[108:111], v[68:71], v[236:239]
    v_mfma_f32_16x16x32_bf16 v[252:255], v[108:111], v[72:75], v[252:255]
    ds_read_b128 v[68:71], v6 offset:20480
    v_mfma_f32_16x16x32_bf16 v[252:255], v[116:119], v[76:79], v[252:255]
    v_mfma_f32_16x16x32_bf16 v[248:251], v[112:115], v[76:79], v[248:251]
    v_mfma_f32_16x16x32_bf16 v[248:251], v[104:107], v[72:75], v[248:251]
    s_waitcnt lgkmcnt(14)
    v_mfma_f32_16x16x32_bf16 v[128:131], v[88:91], v[48:51], v[128:131]
    ds_read_b128 v[72:75], v6 offset:24576
    s_waitcnt lgkmcnt(13)
    v_mfma_f32_16x16x32_bf16 v[128:131], v[96:99], v[52:55], v[128:131]
    s_waitcnt lgkmcnt(8)
    v_mfma_f32_16x16x32_bf16 v[132:135], v[100:103], v[52:55], v[132:135]
    v_mfma_f32_16x16x32_bf16 v[132:135], v[92:95], v[48:51], v[132:135]
    s_waitcnt lgkmcnt(3)
    v_mfma_f32_16x16x32_bf16 v[148:151], v[84:87], v[48:51], v[148:151]
    ds_read_b128 v[76:79], v6 offset:28672
    v_mfma_f32_16x16x32_bf16 v[148:151], v[92:95], v[52:55], v[148:151]
    v_mfma_f32_16x16x32_bf16 v[148:151], v[100:103], v[56:59], v[148:151]
    v_mfma_f32_16x16x32_bf16 v[144:147], v[96:99], v[56:59], v[144:147]
    v_mfma_f32_16x16x32_bf16 v[144:147], v[88:91], v[52:55], v[144:147]
    v_mfma_f32_16x16x32_bf16 v[144:147], v[80:83], v[48:51], v[144:147]
    v_mfma_f32_16x16x32_bf16 v[160:163], v[80:83], v[52:55], v[160:163]
    ds_read_b128 v[48:51], v6 offset:2048
    v_mfma_f32_16x16x32_bf16 v[160:163], v[88:91], v[56:59], v[160:163]
    v_mfma_f32_16x16x32_bf16 v[160:163], v[96:99], v[60:63], v[160:163]
    v_mfma_f32_16x16x32_bf16 v[164:167], v[100:103], v[60:63], v[164:167]
    v_mfma_f32_16x16x32_bf16 v[164:167], v[92:95], v[56:59], v[164:167]
    v_mfma_f32_16x16x32_bf16 v[164:167], v[84:87], v[52:55], v[164:167]
    v_mfma_f32_16x16x32_bf16 v[180:183], v[84:87], v[56:59], v[180:183]
    ds_read_b128 v[52:55], v6 offset:6144
    v_mfma_f32_16x16x32_bf16 v[180:183], v[92:95], v[60:63], v[180:183]
    s_waitcnt lgkmcnt(5)
    v_mfma_f32_16x16x32_bf16 v[180:183], v[100:103], v[64:67], v[180:183]
    v_mfma_f32_16x16x32_bf16 v[176:179], v[96:99], v[64:67], v[176:179]
    v_mfma_f32_16x16x32_bf16 v[176:179], v[88:91], v[60:63], v[176:179]
    v_mfma_f32_16x16x32_bf16 v[176:179], v[80:83], v[56:59], v[176:179]
    v_mfma_f32_16x16x32_bf16 v[192:195], v[80:83], v[60:63], v[192:195]
    ds_read_b128 v[56:59], v6 offset:10240
    v_mfma_f32_16x16x32_bf16 v[192:195], v[88:91], v[64:67], v[192:195]
    s_waitcnt lgkmcnt(5)
    v_mfma_f32_16x16x32_bf16 v[192:195], v[96:99], v[68:71], v[192:195]
    v_mfma_f32_16x16x32_bf16 v[196:199], v[100:103], v[68:71], v[196:199]
    v_mfma_f32_16x16x32_bf16 v[196:199], v[92:95], v[64:67], v[196:199]
    v_mfma_f32_16x16x32_bf16 v[196:199], v[84:87], v[60:63], v[196:199]
    v_mfma_f32_16x16x32_bf16 v[212:215], v[84:87], v[64:67], v[212:215]
    ds_read_b128 v[60:63], v6 offset:14336
    v_mfma_f32_16x16x32_bf16 v[212:215], v[92:95], v[68:71], v[212:215]
    s_waitcnt lgkmcnt(5)
    v_mfma_f32_16x16x32_bf16 v[212:215], v[100:103], v[72:75], v[212:215]
    v_mfma_f32_16x16x32_bf16 v[208:211], v[96:99], v[72:75], v[208:211]
    v_mfma_f32_16x16x32_bf16 v[208:211], v[88:91], v[68:71], v[208:211]
    v_mfma_f32_16x16x32_bf16 v[208:211], v[80:83], v[64:67], v[208:211]
    v_mfma_f32_16x16x32_bf16 v[224:227], v[80:83], v[68:71], v[224:227]
    ds_read_b128 v[64:67], v6 offset:18432
    v_mfma_f32_16x16x32_bf16 v[224:227], v[88:91], v[72:75], v[224:227]
    s_waitcnt lgkmcnt(5)
    v_mfma_f32_16x16x32_bf16 v[224:227], v[96:99], v[76:79], v[224:227]
    v_mfma_f32_16x16x32_bf16 v[228:231], v[100:103], v[76:79], v[228:231]
    v_mfma_f32_16x16x32_bf16 v[228:231], v[92:95], v[72:75], v[228:231]
    v_mfma_f32_16x16x32_bf16 v[228:231], v[84:87], v[68:71], v[228:231]
    v_mfma_f32_16x16x32_bf16 v[244:247], v[84:87], v[72:75], v[244:247]
    ds_read_b128 v[68:71], v6 offset:22528
    v_mfma_f32_16x16x32_bf16 v[244:247], v[92:95], v[76:79], v[244:247]
    v_mfma_f32_16x16x32_bf16 v[240:243], v[88:91], v[76:79], v[240:243]
    v_mfma_f32_16x16x32_bf16 v[240:243], v[80:83], v[72:75], v[240:243]
    s_waitcnt lgkmcnt(5)
    v_mfma_f32_16x16x32_bf16 v[136:139], v[88:91], v[48:51], v[136:139]
    ds_read_b128 v[72:75], v6 offset:26624
    s_waitcnt lgkmcnt(5)
    v_mfma_f32_16x16x32_bf16 v[136:139], v[96:99], v[52:55], v[136:139]
    v_mfma_f32_16x16x32_bf16 v[140:143], v[100:103], v[52:55], v[140:143]
    v_mfma_f32_16x16x32_bf16 v[140:143], v[92:95], v[48:51], v[140:143]
    v_mfma_f32_16x16x32_bf16 v[156:159], v[84:87], v[48:51], v[156:159]
    ds_read_b128 v[76:79], v6 offset:30720
    v_mfma_f32_16x16x32_bf16 v[156:159], v[92:95], v[52:55], v[156:159]
    v_xor_b32 v6, 32768, v6
    s_waitcnt lgkmcnt(5)
    v_mfma_f32_16x16x32_bf16 v[156:159], v[100:103], v[56:59], v[156:159]
    v_mfma_f32_16x16x32_bf16 v[152:155], v[96:99], v[56:59], v[152:155]
    v_mfma_f32_16x16x32_bf16 v[152:155], v[88:91], v[52:55], v[152:155]
    v_mfma_f32_16x16x32_bf16 v[152:155], v[80:83], v[48:51], v[152:155]
    v_mfma_f32_16x16x32_bf16 v[168:171], v[80:83], v[52:55], v[168:171]
    v_mfma_f32_16x16x32_bf16 v[168:171], v[88:91], v[56:59], v[168:171]
    s_waitcnt lgkmcnt(4)
    v_mfma_f32_16x16x32_bf16 v[168:171], v[96:99], v[60:63], v[168:171]
    v_mfma_f32_16x16x32_bf16 v[172:175], v[100:103], v[60:63], v[172:175]
    v_mfma_f32_16x16x32_bf16 v[172:175], v[92:95], v[56:59], v[172:175]
    s_waitcnt lgkmcnt(0)
    v_mfma_f32_16x16x32_bf16 v[172:175], v[84:87], v[52:55], v[172:175]
    s_barrier
    v_mfma_f32_16x16x32_bf16 v[188:191], v[84:87], v[56:59], v[188:191]
    ds_read_b128 v[48:51], v7 offset:0
    v_mfma_f32_16x16x32_bf16 v[188:191], v[92:95], v[60:63], v[188:191]
    ds_read_b128 v[52:55], v7 offset:4096
    v_mfma_f32_16x16x32_bf16 v[188:191], v[100:103], v[64:67], v[188:191]
    ds_read_b64_tr_b16 v[112:113], v8 offset:26624
    v_mfma_f32_16x16x32_bf16 v[184:187], v[96:99], v[64:67], v[184:187]
    ds_read_b64_tr_b16 v[114:115], v8 offset:27648
    v_mfma_f32_16x16x32_bf16 v[184:187], v[88:91], v[60:63], v[184:187]
    ds_read_b64_tr_b16 v[120:121], v8 offset:28672
    v_mfma_f32_16x16x32_bf16 v[184:187], v[80:83], v[56:59], v[184:187]
    ds_read_b64_tr_b16 v[122:123], v8 offset:29696
    v_mfma_f32_16x16x32_bf16 v[200:203], v[80:83], v[60:63], v[200:203]
    ds_read_b128 v[56:59], v7 offset:8192
    v_mfma_f32_16x16x32_bf16 v[200:203], v[88:91], v[64:67], v[200:203]
    ds_read_b64_tr_b16 v[116:117], v9 offset:26624
    v_mfma_f32_16x16x32_bf16 v[200:203], v[96:99], v[68:71], v[200:203]
    ds_read_b64_tr_b16 v[118:119], v9 offset:27648
    v_mfma_f32_16x16x32_bf16 v[204:207], v[100:103], v[68:71], v[204:207]
    ds_read_b64_tr_b16 v[124:125], v9 offset:28672
    v_mfma_f32_16x16x32_bf16 v[204:207], v[92:95], v[64:67], v[204:207]
    ds_read_b64_tr_b16 v[126:127], v9 offset:29696
    v_mfma_f32_16x16x32_bf16 v[204:207], v[84:87], v[60:63], v[204:207]
    ds_read_b64_tr_b16 v[104:105], v8 offset:24576
    v_mfma_f32_16x16x32_bf16 v[220:223], v[84:87], v[64:67], v[220:223]
    ds_read_b128 v[60:63], v7 offset:12288
    v_mfma_f32_16x16x32_bf16 v[220:223], v[92:95], v[68:71], v[220:223]
    ds_read_b64_tr_b16 v[106:107], v8 offset:25600
    v_mfma_f32_16x16x32_bf16 v[220:223], v[100:103], v[72:75], v[220:223]
    ds_read_b64_tr_b16 v[108:109], v9 offset:24576
    v_mfma_f32_16x16x32_bf16 v[216:219], v[96:99], v[72:75], v[216:219]
    ds_read_b64_tr_b16 v[110:111], v9 offset:25600
    v_mfma_f32_16x16x32_bf16 v[216:219], v[88:91], v[68:71], v[216:219]
    v_mfma_f32_16x16x32_bf16 v[216:219], v[80:83], v[64:67], v[216:219]
    v_mfma_f32_16x16x32_bf16 v[232:235], v[80:83], v[68:71], v[232:235]
    ds_read_b128 v[64:67], v7 offset:16384
    v_mfma_f32_16x16x32_bf16 v[232:235], v[88:91], v[72:75], v[232:235]
    v_mfma_f32_16x16x32_bf16 v[232:235], v[96:99], v[76:79], v[232:235]
    v_mfma_f32_16x16x32_bf16 v[236:239], v[100:103], v[76:79], v[236:239]
    v_mfma_f32_16x16x32_bf16 v[236:239], v[92:95], v[72:75], v[236:239]
    v_mfma_f32_16x16x32_bf16 v[236:239], v[84:87], v[68:71], v[236:239]
    v_mfma_f32_16x16x32_bf16 v[252:255], v[84:87], v[72:75], v[252:255]
    ds_read_b128 v[68:71], v7 offset:20480
    v_mfma_f32_16x16x32_bf16 v[252:255], v[92:95], v[76:79], v[252:255]
    s_add_u32 s30, s30, 2
    v_mfma_f32_16x16x32_bf16 v[248:251], v[88:91], v[76:79], v[248:251]
    s_cmp_lt_u32 s30, 28
    v_mfma_f32_16x16x32_bf16 v[248:251], v[80:83], v[72:75], v[248:251]
    s_cbranch_scc1 L_loop
L_tail:
    s_waitcnt lgkmcnt(14)
    v_mfma_f32_16x16x32_bf16 v[128:131], v[112:115], v[48:51], v[128:131]
    v_xor_b32 v1, 32768, v7
    v_add_u32 v8, s29, v8
    s_waitcnt lgkmcnt(9)
    v_mfma_f32_16x16x32_bf16 v[132:135], v[116:119], v[48:51], v[132:135]
    v_add_u32 v9, s29, v9
    s_waitcnt lgkmcnt(4)
    v_mfma_f32_16x16x32_bf16 v[144:147], v[104:107], v[48:51], v[144:147]
    ds_read_b64_tr_b16 v[88:89], v8 offset:2048
    s_waitcnt lgkmcnt(3)
    v_mfma_f32_16x16x32_bf16 v[148:151], v[108:111], v[48:51], v[148:151]
    ds_read_b64_tr_b16 v[90:91], v8 offset:3072
    s_waitcnt vmcnt(0)
    s_mov_b32 s41, 0x37280000
    v_lshlrev_b32 v33, 16, v33
    v_mfma_f32_16x16x32_bf16 v[128:131], v[120:123], v[52:55], v[128:131]
    ds_read_b64_tr_b16 v[92:93], v9 offset:2048
    v_lshlrev_b32 v34, 16, v34
    v_mfma_f32_16x16x32_bf16 v[132:135], v[124:127], v[52:55], v[132:135]
    ds_read_b64_tr_b16 v[94:95], v9 offset:3072
    v_lshlrev_b32 v32, 16, v32
    v_mfma_f32_16x16x32_bf16 v[144:147], v[112:115], v[52:55], v[144:147]
    ds_read_b64_tr_b16 v[80:81], v8 offset:0
    v_lshlrev_b32 v35, 16, v35
    v_mfma_f32_16x16x32_bf16 v[148:151], v[116:119], v[52:55], v[148:151]
    ds_read_b64_tr_b16 v[82:83], v8 offset:1024
    v_add_f32 v33, s41, v33
    v_mfma_f32_16x16x32_bf16 v[160:163], v[104:107], v[52:55], v[160:163]
    ds_read_b64_tr_b16 v[84:85], v9 offset:0
    v_cvt_pk_bf16_f32 v33, v33, v33
    v_mfma_f32_16x16x32_bf16 v[164:167], v[108:111], v[52:55], v[164:167]
    ds_read_b64_tr_b16 v[86:87], v9 offset:1024
    v_and_b32 v33, 0xffff0000, v33
    v_mfma_f32_16x16x32_bf16 v[144:147], v[120:123], v[56:59], v[144:147]
    ds_read_b64_tr_b16 v[96:97], v8 offset:4096
    v_sqrt_f32 v33, v33
    v_mfma_f32_16x16x32_bf16 v[148:151], v[124:127], v[56:59], v[148:151]
    ds_read_b64_tr_b16 v[98:99], v8 offset:5120
    v_cvt_pk_bf16_f32 v33, v33, v33
    v_mfma_f32_16x16x32_bf16 v[160:163], v[112:115], v[56:59], v[160:163]
    ds_read_b64_tr_b16 v[100:101], v9 offset:4096
    v_and_b32 v33, 0xffff0000, v33
    v_mfma_f32_16x16x32_bf16 v[164:167], v[116:119], v[56:59], v[164:167]
    ds_read_b64_tr_b16 v[102:103], v9 offset:5120
    v_rcp_f32 v33, v33
    v_mfma_f32_16x16x32_bf16 v[176:179], v[104:107], v[56:59], v[176:179]
    v_cvt_pk_bf16_f32 v33, v33, v33
    v_mfma_f32_16x16x32_bf16 v[180:183], v[108:111], v[56:59], v[180:183]
    v_and_b32 v33, 0xffff0000, v33
    v_mfma_f32_16x16x32_bf16 v[160:163], v[120:123], v[60:63], v[160:163]
    v_mul_f32 v33, v33, v34
    v_mfma_f32_16x16x32_bf16 v[164:167], v[124:127], v[60:63], v[164:167]
    v_cvt_pk_bf16_f32 v33, v33, v33
    v_mfma_f32_16x16x32_bf16 v[176:179], v[112:115], v[60:63], v[176:179]
    s_barrier
    v_and_b32 v33, 0xffff0000, v33
    v_mfma_f32_16x16x32_bf16 v[180:183], v[116:119], v[60:63], v[180:183]
    ds_read_b128 v[48:51], v6 offset:0
    v_fma_f32 v35, -v32, v33, v35
    v_mfma_f32_16x16x32_bf16 v[192:195], v[104:107], v[60:63], v[192:195]
    ds_read_b128 v[52:55], v1 offset:0
    v_mul_f32 v33, s38, v33
    v_mfma_f32_16x16x32_bf16 v[196:199], v[108:111], v[60:63], v[196:199]
    ds_read_b128 v[56:59], v6 offset:4096
    v_mul_f32 v35, s38, v35
    s_waitcnt lgkmcnt(14)
    v_mfma_f32_16x16x32_bf16 v[176:179], v[120:123], v[64:67], v[176:179]
    ds_read_b128 v[60:63], v1 offset:4096
    s_nop 1
    v_mov_b32_dpp v16, v33 row_newbcast:0 row_mask:0xf bank_mask:0xf
    v_mfma_f32_16x16x32_bf16 v[180:183], v[124:127], v[64:67], v[180:183]
    ds_read_b64_tr_b16 v[72:73], v8 offset:26624
    v_mov_b32_dpp v17, v33 row_newbcast:1 row_mask:0xf bank_mask:0xf
    v_mfma_f32_16x16x32_bf16 v[192:195], v[112:115], v[64:67], v[192:195]
    ds_read_b64_tr_b16 v[74:75], v8 offset:27648
    v_mov_b32_dpp v18, v33 row_newbcast:2 row_mask:0xf bank_mask:0xf
    v_mfma_f32_16x16x32_bf16 v[196:199], v[116:119], v[64:67], v[196:199]
    ds_read_b64_tr_b16 v[76:77], v9 offset:26624
    v_mov_b32_dpp v19, v33 row_newbcast:3 row_mask:0xf bank_mask:0xf
    v_mfma_f32_16x16x32_bf16 v[208:211], v[104:107], v[64:67], v[208:211]
    ds_read_b64_tr_b16 v[78:79], v9 offset:27648
    v_mov_b32_dpp v20, v33 row_newbcast:4 row_mask:0xf bank_mask:0xf
    v_mfma_f32_16x16x32_bf16 v[212:215], v[108:111], v[64:67], v[212:215]
    ds_read_b64_tr_b16 v[40:41], v8 offset:24576
    v_mov_b32_dpp v21, v33 row_newbcast:5 row_mask:0xf bank_mask:0xf
    v_mfma_f32_16x16x32_bf16 v[192:195], v[120:123], v[68:71], v[192:195]
    ds_read_b128 v[64:67], v6 offset:8192
    v_mov_b32_dpp v22, v33 row_newbcast:6 row_mask:0xf bank_mask:0xf
    v_mfma_f32_16x16x32_bf16 v[196:199], v[124:127], v[68:71], v[196:199]
    ds_read_b64_tr_b16 v[42:43], v8 offset:25600
    v_mov_b32_dpp v23, v33 row_newbcast:7 row_mask:0xf bank_mask:0xf
    v_mfma_f32_16x16x32_bf16 v[208:211], v[112:115], v[68:71], v[208:211]
    ds_read_b64_tr_b16 v[44:45], v9 offset:24576
    v_mov_b32_dpp v24, v35 row_newbcast:0 row_mask:0xf bank_mask:0xf
    v_mfma_f32_16x16x32_bf16 v[212:215], v[116:119], v[68:71], v[212:215]
    ds_read_b64_tr_b16 v[46:47], v9 offset:25600
    v_mov_b32_dpp v25, v35 row_newbcast:1 row_mask:0xf bank_mask:0xf
    v_mfma_f32_16x16x32_bf16 v[224:227], v[104:107], v[68:71], v[224:227]
    ds_read_b64_tr_b16 v[2:3], v8 offset:28672
    v_mov_b32_dpp v26, v35 row_newbcast:2 row_mask:0xf bank_mask:0xf
    v_mfma_f32_16x16x32_bf16 v[228:231], v[108:111], v[68:71], v[228:231]
    ds_read_b64_tr_b16 v[4:5], v8 offset:29696
    v_mov_b32_dpp v27, v35 row_newbcast:3 row_mask:0xf bank_mask:0xf
    s_waitcnt lgkmcnt(14)
    v_mfma_f32_16x16x32_bf16 v[128:131], v[88:91], v[48:51], v[128:131]
    ds_read_b128 v[68:71], v1 offset:8192
    v_mov_b32_dpp v28, v35 row_newbcast:4 row_mask:0xf bank_mask:0xf
    s_waitcnt lgkmcnt(10)
    v_mfma_f32_16x16x32_bf16 v[128:131], v[72:75], v[52:55], v[128:131]
    ds_read_b64_tr_b16 v[12:13], v9 offset:28672
    v_mov_b32_dpp v29, v35 row_newbcast:5 row_mask:0xf bank_mask:0xf
    v_mfma_f32_16x16x32_bf16 v[132:135], v[92:95], v[48:51], v[132:135]
    ds_read_b64_tr_b16 v[14:15], v9 offset:29696
    v_mov_b32_dpp v30, v35 row_newbcast:6 row_mask:0xf bank_mask:0xf
    s_waitcnt lgkmcnt(10)
    v_mfma_f32_16x16x32_bf16 v[132:135], v[76:79], v[52:55], v[132:135]
    v_mov_b32_dpp v31, v35 row_newbcast:7 row_mask:0xf bank_mask:0xf
    v_mfma_f32_16x16x32_bf16 v[144:147], v[80:83], v[48:51], v[144:147]
    s_waitcnt lgkmcnt(7)
    v_mfma_f32_16x16x32_bf16 v[144:147], v[40:43], v[52:55], v[144:147]
    v_mfma_f32_16x16x32_bf16 v[148:151], v[84:87], v[48:51], v[148:151]
    s_waitcnt lgkmcnt(5)
    v_mfma_f32_16x16x32_bf16 v[148:151], v[44:47], v[52:55], v[148:151]
    v_mfma_f32_16x16x32_bf16 v[128:131], v[96:99], v[56:59], v[128:131]
    ds_read_b128 v[48:51], v6 offset:12288
    s_waitcnt lgkmcnt(4)
    v_mfma_f32_16x16x32_bf16 v[128:131], v[2:5], v[60:63], v[128:131]
    ds_read_b128 v[52:55], v1 offset:12288
    v_mfma_f32_16x16x32_bf16 v[132:135], v[100:103], v[56:59], v[132:135]
    s_waitcnt lgkmcnt(2)
    v_mfma_f32_16x16x32_bf16 v[132:135], v[12:15], v[60:63], v[132:135]
    v_mfma_f32_16x16x32_bf16 v[144:147], v[88:91], v[56:59], v[144:147]
    v_mfma_f32_16x16x32_bf16 v[144:147], v[72:75], v[60:63], v[144:147]
    v_mfma_f32_16x16x32_bf16 v[148:151], v[92:95], v[56:59], v[148:151]
    v_mfma_f32_16x16x32_bf16 v[148:151], v[76:79], v[60:63], v[148:151]
    v_mfma_f32_16x16x32_bf16 v[160:163], v[80:83], v[56:59], v[160:163]
    v_fma_f32 v128, v128, v16, v24
    v_fma_f32 v129, v129, v17, v25
    v_mfma_f32_16x16x32_bf16 v[160:163], v[40:43], v[60:63], v[160:163]
    v_fma_f32 v130, v130, v18, v26
    v_fma_f32 v131, v131, v19, v27
    v_mfma_f32_16x16x32_bf16 v[164:167], v[84:87], v[56:59], v[164:167]
    v_fma_f32 v132, v132, v20, v28
    v_fma_f32 v133, v133, v21, v29
    v_mfma_f32_16x16x32_bf16 v[164:167], v[44:47], v[60:63], v[164:167]
    v_fma_f32 v134, v134, v22, v30
    v_fma_f32 v135, v135, v23, v31
    v_mfma_f32_16x16x32_bf16 v[144:147], v[96:99], v[64:67], v[144:147]
    ds_read_b128 v[56:59], v6 offset:16384
    v_mfma_f32_16x16x32_bf16 v[144:147], v[2:5], v[68:71], v[144:147]
    ds_read_b128 v[60:63], v1 offset:16384
    v_mfma_f32_16x16x32_bf16 v[148:151], v[100:103], v[64:67], v[148:151]
    v_exp_f32 v32, v128
    v_mfma_f32_16x16x32_bf16 v[148:151], v[12:15], v[68:71], v[148:151]
    v_exp_f32 v33, v129
    v_mfma_f32_16x16x32_bf16 v[160:163], v[88:91], v[64:67], v[160:163]
    v_exp_f32 v34, v130
    v_mfma_f32_16x16x32_bf16 v[160:163], v[72:75], v[68:71], v[160:163]
    v_exp_f32 v35, v131
    v_mfma_f32_16x16x32_bf16 v[164:167], v[92:95], v[64:67], v[164:167]
    v_exp_f32 v36, v132
    v_mfma_f32_16x16x32_bf16 v[164:167], v[76:79], v[68:71], v[164:167]
    v_exp_f32 v37, v133
    v_mfma_f32_16x16x32_bf16 v[176:179], v[80:83], v[64:67], v[176:179]
    v_exp_f32 v38, v134
    v_mfma_f32_16x16x32_bf16 v[176:179], v[40:43], v[68:71], v[176:179]
    v_exp_f32 v39, v135
    v_mfma_f32_16x16x32_bf16 v[180:183], v[84:87], v[64:67], v[180:183]
    v_fma_f32 v32, v32, s38, s38
    v_fma_f32 v33, v33, s38, s38
    v_mfma_f32_16x16x32_bf16 v[180:183], v[44:47], v[68:71], v[180:183]
    v_fma_f32 v34, v34, s38, s38
    v_fma_f32 v35, v35, s38, s38
    s_waitcnt lgkmcnt(3)
    v_mfma_f32_16x16x32_bf16 v[160:163], v[96:99], v[48:51], v[160:163]
    ds_read_b128 v[64:67], v6 offset:20480
    v_fma_f32 v36, v36, s38, s38
    s_waitcnt lgkmcnt(3)
    v_mfma_f32_16x16x32_bf16 v[160:163], v[2:5], v[52:55], v[160:163]
    ds_read_b128 v[68:71], v1 offset:20480
    v_fma_f32 v37, v37, s38, s38
    v_mfma_f32_16x16x32_bf16 v[164:167], v[100:103], v[48:51], v[164:167]
    v_fma_f32 v38, v38, s38, s38
    v_fma_f32 v39, v39, s38, s38
    v_mfma_f32_16x16x32_bf16 v[164:167], v[12:15], v[52:55], v[164:167]
    v_rcp_f32 v32, v32
    v_mfma_f32_16x16x32_bf16 v[176:179], v[88:91], v[48:51], v[176:179]
    v_rcp_f32 v33, v33
    v_mfma_f32_16x16x32_bf16 v[176:179], v[72:75], v[52:55], v[176:179]
    v_rcp_f32 v34, v34
    v_mfma_f32_16x16x32_bf16 v[180:183], v[92:95], v[48:51], v[180:183]
    v_rcp_f32 v35, v35
    v_mfma_f32_16x16x32_bf16 v[180:183], v[76:79], v[52:55], v[180:183]
    v_rcp_f32 v36, v36
    v_mfma_f32_16x16x32_bf16 v[192:195], v[80:83], v[48:51], v[192:195]
    v_rcp_f32 v37, v37
    v_mfma_f32_16x16x32_bf16 v[192:195], v[40:43], v[52:55], v[192:195]
    v_rcp_f32 v38, v38
    v_mfma_f32_16x16x32_bf16 v[196:199], v[84:87], v[48:51], v[196:199]
    v_rcp_f32 v39, v39
    v_mfma_f32_16x16x32_bf16 v[196:199], v[44:47], v[52:55], v[196:199]
    v_mul_f32 v128, v128, v32
    v_mul_f32 v129, v129, v33
    s_waitcnt lgkmcnt(3)
    v_mfma_f32_16x16x32_bf16 v[176:179], v[96:99], v[56:59], v[176:179]
    ds_read_b128 v[48:51], v7 offset:24576
    v_mul_f32 v130, v130, v34
    s_waitcnt lgkmcnt(3)
    v_mfma_f32_16x16x32_bf16 v[176:179], v[2:5], v[60:63], v[176:179]
    ds_read_b128 v[52:55], v6 offset:24576
    v_mul_f32 v131, v131, v35
    v_mfma_f32_16x16x32_bf16 v[180:183], v[100:103], v[56:59], v[180:183]
    v_mul_f32 v132, v132, v36
    v_mul_f32 v133, v133, v37
    v_mfma_f32_16x16x32_bf16 v[180:183], v[12:15], v[60:63], v[180:183]
    v_mul_f32 v134, v134, v38
    v_mul_f32 v135, v135, v39
    v_mfma_f32_16x16x32_bf16 v[192:195], v[88:91], v[56:59], v[192:195]
    v_cvt_pk_bf16_f32 v128, v128, v129
    v_cvt_pk_bf16_f32 v129, v130, v131
    v_mfma_f32_16x16x32_bf16 v[192:195], v[72:75], v[60:63], v[192:195]
    v_cvt_pk_bf16_f32 v130, v132, v133
    v_cvt_pk_bf16_f32 v131, v134, v135
    v_mfma_f32_16x16x32_bf16 v[196:199], v[92:95], v[56:59], v[196:199]
    s_mov_b32 s60, 0
    v_permlane16_swap_b32 v128, v130
    v_permlane16_swap_b32 v129, v131
    v_mfma_f32_16x16x32_bf16 v[196:199], v[76:79], v[60:63], v[196:199]
    buffer_store_dwordx4 v[128:131], v11, s[16:19], s60 offen sc1
    v_fma_f32 v144, v144, v16, v24
    v_mfma_f32_16x16x32_bf16 v[208:211], v[80:83], v[56:59], v[208:211]
    v_fma_f32 v145, v145, v17, v25
    v_fma_f32 v146, v146, v18, v26
    v_mfma_f32_16x16x32_bf16 v[208:211], v[40:43], v[60:63], v[208:211]
    v_fma_f32 v147, v147, v19, v27
    v_fma_f32 v148, v148, v20, v28
    v_mfma_f32_16x16x32_bf16 v[212:215], v[84:87], v[56:59], v[212:215]
    v_fma_f32 v149, v149, v21, v29
    v_fma_f32 v150, v150, v22, v30
    v_mfma_f32_16x16x32_bf16 v[212:215], v[44:47], v[60:63], v[212:215]
    v_fma_f32 v151, v151, v23, v31
    s_waitcnt lgkmcnt(3)
    v_mfma_f32_16x16x32_bf16 v[192:195], v[96:99], v[64:67], v[192:195]
    ds_read_b128 v[56:59], v1 offset:24576
    s_waitcnt lgkmcnt(3)
    v_mfma_f32_16x16x32_bf16 v[192:195], v[2:5], v[68:71], v[192:195]
    ds_read_b128 v[60:63], v7 offset:28672
    v_mfma_f32_16x16x32_bf16 v[196:199], v[100:103], v[64:67], v[196:199]
    v_exp_f32 v32, v144
    v_mfma_f32_16x16x32_bf16 v[196:199], v[12:15], v[68:71], v[196:199]
    v_exp_f32 v33, v145
    v_mfma_f32_16x16x32_bf16 v[208:211], v[88:91], v[64:67], v[208:211]
    v_exp_f32 v34, v146
    v_mfma_f32_16x16x32_bf16 v[208:211], v[72:75], v[68:71], v[208:211]
    v_exp_f32 v35, v147
    v_mfma_f32_16x16x32_bf16 v[212:215], v[92:95], v[64:67], v[212:215]
    v_exp_f32 v36, v148
    v_mfma_f32_16x16x32_bf16 v[212:215], v[76:79], v[68:71], v[212:215]
    v_exp_f32 v37, v149
    v_mfma_f32_16x16x32_bf16 v[224:227], v[80:83], v[64:67], v[224:227]
    v_exp_f32 v38, v150
    v_mfma_f32_16x16x32_bf16 v[224:227], v[40:43], v[68:71], v[224:227]
    v_exp_f32 v39, v151
    v_mfma_f32_16x16x32_bf16 v[228:231], v[84:87], v[64:67], v[228:231]
    v_fma_f32 v32, v32, s38, s38
    v_fma_f32 v33, v33, s38, s38
    v_mfma_f32_16x16x32_bf16 v[228:231], v[44:47], v[68:71], v[228:231]
    v_fma_f32 v34, v34, s38, s38
    v_fma_f32 v35, v35, s38, s38
    s_waitcnt lgkmcnt(3)
    v_mfma_f32_16x16x32_bf16 v[208:211], v[120:123], v[48:51], v[208:211]
    ds_read_b128 v[64:67], v6 offset:28672
    v_fma_f32 v36, v36, s38, s38
    s_waitcnt lgkmcnt(3)
    v_mfma_f32_16x16x32_bf16 v[208:211], v[96:99], v[52:55], v[208:211]
    ds_read_b128 v[68:71], v1 offset:28672
    v_fma_f32 v37, v37, s38, s38
    s_waitcnt lgkmcnt(3)
    v_mfma_f32_16x16x32_bf16 v[208:211], v[2:5], v[56:59], v[208:211]
    v_fma_f32 v38, v38, s38, s38
    v_fma_f32 v39, v39, s38, s38
    v_mfma_f32_16x16x32_bf16 v[212:215], v[124:127], v[48:51], v[212:215]
    v_rcp_f32 v32, v32
    v_mfma_f32_16x16x32_bf16 v[212:215], v[100:103], v[52:55], v[212:215]
    v_rcp_f32 v33, v33
    v_mfma_f32_16x16x32_bf16 v[212:215], v[12:15], v[56:59], v[212:215]
    v_rcp_f32 v34, v34
    v_mfma_f32_16x16x32_bf16 v[224:227], v[112:115], v[48:51], v[224:227]
    v_rcp_f32 v35, v35
    v_mfma_f32_16x16x32_bf16 v[224:227], v[88:91], v[52:55], v[224:227]
    v_rcp_f32 v36, v36
    v_mfma_f32_16x16x32_bf16 v[224:227], v[72:75], v[56:59], v[224:227]
    v_rcp_f32 v37, v37
    v_mfma_f32_16x16x32_bf16 v[228:231], v[116:119], v[48:51], v[228:231]
    v_rcp_f32 v38, v38
    v_mfma_f32_16x16x32_bf16 v[228:231], v[92:95], v[52:55], v[228:231]
    v_rcp_f32 v39, v39
    v_mfma_f32_16x16x32_bf16 v[228:231], v[76:79], v[56:59], v[228:231]
    v_mul_f32 v144, v144, v32
    v_mul_f32 v145, v145, v33
    v_mfma_f32_16x16x32_bf16 v[240:243], v[104:107], v[48:51], v[240:243]
    v_mul_f32 v146, v146, v34
    v_mul_f32 v147, v147, v35
    v_mfma_f32_16x16x32_bf16 v[240:243], v[80:83], v[52:55], v[240:243]
    v_mul_f32 v148, v148, v36
    v_mul_f32 v149, v149, v37
    v_mfma_f32_16x16x32_bf16 v[240:243], v[40:43], v[56:59], v[240:243]
    v_mul_f32 v150, v150, v38
    v_mul_f32 v151, v151, v39
    v_mfma_f32_16x16x32_bf16 v[244:247], v[108:111], v[48:51], v[244:247]
    v_cvt_pk_bf16_f32 v144, v144, v145
    v_cvt_pk_bf16_f32 v145, v146, v147
    v_mfma_f32_16x16x32_bf16 v[244:247], v[84:87], v[52:55], v[244:247]
    v_cvt_pk_bf16_f32 v146, v148, v149
    v_cvt_pk_bf16_f32 v147, v150, v151
    v_mfma_f32_16x16x32_bf16 v[244:247], v[44:47], v[56:59], v[244:247]
    s_mov_b32 s61, 2048
    v_permlane16_swap_b32 v144, v146
    v_permlane16_swap_b32 v145, v147
    s_waitcnt lgkmcnt(2)
    v_mfma_f32_16x16x32_bf16 v[224:227], v[120:123], v[60:63], v[224:227]
    ds_read_b128 v[48:51], v7 offset:2048
    buffer_store_dwordx4 v[144:147], v11, s[16:19], s61 offen sc1
    s_waitcnt lgkmcnt(2)
    v_mfma_f32_16x16x32_bf16 v[224:227], v[96:99], v[64:67], v[224:227]
    ds_read_b128 v[52:55], v6 offset:2048
    v_fma_f32 v160, v160, v16, v24
    s_waitcnt lgkmcnt(2)
    v_mfma_f32_16x16x32_bf16 v[224:227], v[2:5], v[68:71], v[224:227]
    ds_read_b128 v[56:59], v1 offset:2048
    v_fma_f32 v161, v161, v17, v25
    v_mfma_f32_16x16x32_bf16 v[228:231], v[124:127], v[60:63], v[228:231]
    v_fma_f32 v162, v162, v18, v26
    v_fma_f32 v163, v163, v19, v27
    v_mfma_f32_16x16x32_bf16 v[228:231], v[100:103], v[64:67], v[228:231]
    v_fma_f32 v164, v164, v20, v28
    v_fma_f32 v165, v165, v21, v29
    v_mfma_f32_16x16x32_bf16 v[228:231], v[12:15], v[68:71], v[228:231]
    v_fma_f32 v166, v166, v22, v30
    v_fma_f32 v167, v167, v23, v31
    v_mfma_f32_16x16x32_bf16 v[240:243], v[112:115], v[60:63], v[240:243]
    v_exp_f32 v32, v160
    v_mfma_f32_16x16x32_bf16 v[240:243], v[88:91], v[64:67], v[240:243]
    v_exp_f32 v33, v161
    v_mfma_f32_16x16x32_bf16 v[240:243], v[72:75], v[68:71], v[240:243]
    v_exp_f32 v34, v162
    v_mfma_f32_16x16x32_bf16 v[244:247], v[116:119], v[60:63], v[244:247]
    v_exp_f32 v35, v163
    v_mfma_f32_16x16x32_bf16 v[244:247], v[92:95], v[64:67], v[244:247]
    v_exp_f32 v36, v164
    v_mfma_f32_16x16x32_bf16 v[244:247], v[76:79], v[68:71], v[244:247]
    v_exp_f32 v37, v165
    s_waitcnt lgkmcnt(2)
    v_mfma_f32_16x16x32_bf16 v[136:139], v[112:115], v[48:51], v[136:139]
    ds_read_b128 v[60:63], v7 offset:6144
    s_waitcnt lgkmcnt(2)
    v_mfma_f32_16x16x32_bf16 v[136:139], v[88:91], v[52:55], v[136:139]
    ds_read_b128 v[64:67], v6 offset:6144
    s_waitcnt lgkmcnt(2)
    v_mfma_f32_16x16x32_bf16 v[136:139], v[72:75], v[56:59], v[136:139]
    ds_read_b128 v[68:71], v1 offset:6144
    v_mfma_f32_16x16x32_bf16 v[140:143], v[116:119], v[48:51], v[140:143]
    v_exp_f32 v38, v166
    v_mfma_f32_16x16x32_bf16 v[140:143], v[92:95], v[52:55], v[140:143]
    v_exp_f32 v39, v167
    v_mfma_f32_16x16x32_bf16 v[140:143], v[76:79], v[56:59], v[140:143]
    v_fma_f32 v32, v32, s38, s38
    v_fma_f32 v33, v33, s38, s38
    v_mfma_f32_16x16x32_bf16 v[152:155], v[104:107], v[48:51], v[152:155]
    v_fma_f32 v34, v34, s38, s38
    v_fma_f32 v35, v35, s38, s38
    v_mfma_f32_16x16x32_bf16 v[152:155], v[80:83], v[52:55], v[152:155]
    v_fma_f32 v36, v36, s38, s38
    v_fma_f32 v37, v37, s38, s38
    v_mfma_f32_16x16x32_bf16 v[152:155], v[40:43], v[56:59], v[152:155]
    v_fma_f32 v38, v38, s38, s38
    v_fma_f32 v39, v39, s38, s38
    v_mfma_f32_16x16x32_bf16 v[156:159], v[108:111], v[48:51], v[156:159]
    v_rcp_f32 v32, v32
    v_mfma_f32_16x16x32_bf16 v[156:159], v[84:87], v[52:55], v[156:159]
    v_rcp_f32 v33, v33
    v_mfma_f32_16x16x32_bf16 v[156:159], v[44:47], v[56:59], v[156:159]
    v_rcp_f32 v34, v34
    s_waitcnt lgkmcnt(2)
    v_mfma_f32_16x16x32_bf16 v[136:139], v[120:123], v[60:63], v[136:139]
    ds_read_b128 v[48:51], v7 offset:10240
    s_waitcnt lgkmcnt(2)
    v_mfma_f32_16x16x32_bf16 v[136:139], v[96:99], v[64:67], v[136:139]
    ds_read_b128 v[52:55], v6 offset:10240
    s_waitcnt lgkmcnt(2)
    v_mfma_f32_16x16x32_bf16 v[136:139], v[2:5], v[68:71], v[136:139]
    ds_read_b128 v[56:59], v1 offset:10240
    v_mfma_f32_16x16x32_bf16 v[140:143], v[124:127], v[60:63], v[140:143]
    v_rcp_f32 v35, v35
    v_mfma_f32_16x16x32_bf16 v[140:143], v[100:103], v[64:67], v[140:143]
    v_rcp_f32 v36, v36
    v_mfma_f32_16x16x32_bf16 v[140:143], v[12:15], v[68:71], v[140:143]
    v_rcp_f32 v37, v37
    v_mfma_f32_16x16x32_bf16 v[152:155], v[112:115], v[60:63], v[152:155]
    v_rcp_f32 v38, v38
    v_mfma_f32_16x16x32_bf16 v[152:155], v[88:91], v[64:67], v[152:155]
    v_rcp_f32 v39, v39
    v_mfma_f32_16x16x32_bf16 v[152:155], v[72:75], v[68:71], v[152:155]
    v_mul_f32 v160, v160, v32
    v_mul_f32 v161, v161, v33
    v_mfma_f32_16x16x32_bf16 v[156:159], v[116:119], v[60:63], v[156:159]
    v_mul_f32 v162, v162, v34
    v_mul_f32 v163, v163, v35
    v_mfma_f32_16x16x32_bf16 v[156:159], v[92:95], v[64:67], v[156:159]
    v_mul_f32 v164, v164, v36
    v_mul_f32 v165, v165, v37
    v_mfma_f32_16x16x32_bf16 v[156:159], v[76:79], v[68:71], v[156:159]
    v_mul_f32 v166, v166, v38
    v_mul_f32 v167, v167, v39
    v_mfma_f32_16x16x32_bf16 v[168:171], v[104:107], v[60:63], v[168:171]
    v_cvt_pk_bf16_f32 v160, v160, v161
    v_cvt_pk_bf16_f32 v161, v162, v163
    v_mfma_f32_16x16x32_bf16 v[168:171], v[80:83], v[64:67], v[168:171]
    v_cvt_pk_bf16_f32 v162, v164, v165
    v_cvt_pk_bf16_f32 v163, v166, v167
    v_mfma_f32_16x16x32_bf16 v[168:171], v[40:43], v[68:71], v[168:171]
    s_mov_b32 s62, 4096
    v_permlane16_swap_b32 v160, v162
    v_permlane16_swap_b32 v161, v163
    v_mfma_f32_16x16x32_bf16 v[172:175], v[108:111], v[60:63], v[172:175]
    buffer_store_dwordx4 v[160:163], v11, s[16:19], s62 offen sc1
    v_fma_f32 v176, v176, v16, v24
    v_mfma_f32_16x16x32_bf16 v[172:175], v[84:87], v[64:67], v[172:175]
    v_fma_f32 v177, v177, v17, v25
    v_fma_f32 v178, v178, v18, v26
    v_mfma_f32_16x16x32_bf16 v[172:175], v[44:47], v[68:71], v[172:175]
    v_fma_f32 v179, v179, v19, v27
    v_fma_f32 v180, v180, v20, v28
    s_waitcnt lgkmcnt(2)
    v_mfma_f32_16x16x32_bf16 v[152:155], v[120:123], v[48:51], v[152:155]
    ds_read_b128 v[60:63], v7 offset:14336
    v_fma_f32 v181, v181, v21, v29
    s_waitcnt lgkmcnt(2)
    v_mfma_f32_16x16x32_bf16 v[152:155], v[96:99], v[52:55], v[152:155]
    ds_read_b128 v[64:67], v6 offset:14336
    v_fma_f32 v182, v182, v22, v30
    s_waitcnt lgkmcnt(2)
    v_mfma_f32_16x16x32_bf16 v[152:155], v[2:5], v[56:59], v[152:155]
    ds_read_b128 v[68:71], v1 offset:14336
    v_fma_f32 v183, v183, v23, v31
    v_mfma_f32_16x16x32_bf16 v[156:159], v[124:127], v[48:51], v[156:159]
    v_exp_f32 v32, v176
    v_mfma_f32_16x16x32_bf16 v[156:159], v[100:103], v[52:55], v[156:159]
    v_exp_f32 v33, v177
    v_mfma_f32_16x16x32_bf16 v[156:159], v[12:15], v[56:59], v[156:159]
    v_exp_f32 v34, v178
    v_mfma_f32_16x16x32_bf16 v[168:171], v[112:115], v[48:51], v[168:171]
    v_exp_f32 v35, v179
    v_mfma_f32_16x16x32_bf16 v[168:171], v[88:91], v[52:55], v[168:171]
    v_exp_f32 v36, v180
    v_mfma_f32_16x16x32_bf16 v[168:171], v[72:75], v[56:59], v[168:171]
    v_exp_f32 v37, v181
    v_mfma_f32_16x16x32_bf16 v[172:175], v[116:119], v[48:51], v[172:175]
    v_exp_f32 v38, v182
    v_mfma_f32_16x16x32_bf16 v[172:175], v[92:95], v[52:55], v[172:175]
    v_exp_f32 v39, v183
    v_mfma_f32_16x16x32_bf16 v[172:175], v[76:79], v[56:59], v[172:175]
    v_fma_f32 v32, v32, s38, s38
    v_fma_f32 v33, v33, s38, s38
    v_mfma_f32_16x16x32_bf16 v[184:187], v[104:107], v[48:51], v[184:187]
    v_fma_f32 v34, v34, s38, s38
    v_fma_f32 v35, v35, s38, s38
    v_mfma_f32_16x16x32_bf16 v[184:187], v[80:83], v[52:55], v[184:187]
    v_fma_f32 v36, v36, s38, s38
    v_fma_f32 v37, v37, s38, s38
    v_mfma_f32_16x16x32_bf16 v[184:187], v[40:43], v[56:59], v[184:187]
    v_fma_f32 v38, v38, s38, s38
    v_fma_f32 v39, v39, s38, s38
    v_mfma_f32_16x16x32_bf16 v[188:191], v[108:111], v[48:51], v[188:191]
    v_rcp_f32 v32, v32
    v_mfma_f32_16x16x32_bf16 v[188:191], v[84:87], v[52:55], v[188:191]
    v_rcp_f32 v33, v33
    v_mfma_f32_16x16x32_bf16 v[188:191], v[44:47], v[56:59], v[188:191]
    v_rcp_f32 v34, v34
    s_waitcnt lgkmcnt(2)
    v_mfma_f32_16x16x32_bf16 v[168:171], v[120:123], v[60:63], v[168:171]
    ds_read_b128 v[48:51], v7 offset:18432
    s_waitcnt lgkmcnt(2)
    v_mfma_f32_16x16x32_bf16 v[168:171], v[96:99], v[64:67], v[168:171]
    ds_read_b128 v[52:55], v6 offset:18432
    s_waitcnt lgkmcnt(2)
    v_mfma_f32_16x16x32_bf16 v[168:171], v[2:5], v[68:71], v[168:171]
    ds_read_b128 v[56:59], v1 offset:18432
    v_mfma_f32_16x16x32_bf16 v[172:175], v[124:127], v[60:63], v[172:175]
    v_rcp_f32 v35, v35
    v_mfma_f32_16x16x32_bf16 v[172:175], v[100:103], v[64:67], v[172:175]
    v_rcp_f32 v36, v36
    v_mfma_f32_16x16x32_bf16 v[172:175], v[12:15], v[68:71], v[172:175]
    v_rcp_f32 v37, v37
    v_mfma_f32_16x16x32_bf16 v[184:187], v[112:115], v[60:63], v[184:187]
    v_rcp_f32 v38, v38
    v_mfma_f32_16x16x32_bf16 v[184:187], v[88:91], v[64:67], v[184:187]
    v_rcp_f32 v39, v39
    v_mfma_f32_16x16x32_bf16 v[184:187], v[72:75], v[68:71], v[184:187]
    v_mul_f32 v176, v176, v32
    v_mul_f32 v177, v177, v33
    v_mfma_f32_16x16x32_bf16 v[188:191], v[116:119], v[60:63], v[188:191]
    v_mul_f32 v178, v178, v34
    v_mul_f32 v179, v179, v35
    v_mfma_f32_16x16x32_bf16 v[188:191], v[92:95], v[64:67], v[188:191]
    v_mul_f32 v180, v180, v36
    v_mul_f32 v181, v181, v37
    v_mfma_f32_16x16x32_bf16 v[188:191], v[76:79], v[68:71], v[188:191]
    v_mul_f32 v182, v182, v38
    v_mul_f32 v183, v183, v39
    v_mfma_f32_16x16x32_bf16 v[200:203], v[104:107], v[60:63], v[200:203]
    v_cvt_pk_bf16_f32 v176, v176, v177
    v_cvt_pk_bf16_f32 v177, v178, v179
    v_mfma_f32_16x16x32_bf16 v[200:203], v[80:83], v[64:67], v[200:203]
    v_cvt_pk_bf16_f32 v178, v180, v181
    v_cvt_pk_bf16_f32 v179, v182, v183
    v_mfma_f32_16x16x32_bf16 v[200:203], v[40:43], v[68:71], v[200:203]
    s_mov_b32 s63, 6144
    v_permlane16_swap_b32 v176, v178
    v_permlane16_swap_b32 v177, v179
    v_mfma_f32_16x16x32_bf16 v[204:207], v[108:111], v[60:63], v[204:207]
    buffer_store_dwordx4 v[176:179], v11, s[16:19], s63 offen sc1
    v_fma_f32 v192, v192, v16, v24
    v_mfma_f32_16x16x32_bf16 v[204:207], v[84:87], v[64:67], v[204:207]
    v_fma_f32 v193, v193, v17, v25
    v_fma_f32 v194, v194, v18, v26
    v_mfma_f32_16x16x32_bf16 v[204:207], v[44:47], v[68:71], v[204:207]
    v_fma_f32 v195, v195, v19, v27
    v_fma_f32 v196, v196, v20, v28
    s_waitcnt lgkmcnt(2)
    v_mfma_f32_16x16x32_bf16 v[184:187], v[120:123], v[48:51], v[184:187]
    ds_read_b128 v[60:63], v7 offset:22528
    v_fma_f32 v197, v197, v21, v29
    s_waitcnt lgkmcnt(2)
    v_mfma_f32_16x16x32_bf16 v[184:187], v[96:99], v[52:55], v[184:187]
    ds_read_b128 v[64:67], v6 offset:22528
    v_fma_f32 v198, v198, v22, v30
    s_waitcnt lgkmcnt(2)
    v_mfma_f32_16x16x32_bf16 v[184:187], v[2:5], v[56:59], v[184:187]
    ds_read_b128 v[68:71], v1 offset:22528
    v_fma_f32 v199, v199, v23, v31
    v_mfma_f32_16x16x32_bf16 v[188:191], v[124:127], v[48:51], v[188:191]
    v_exp_f32 v32, v192
    v_mfma_f32_16x16x32_bf16 v[188:191], v[100:103], v[52:55], v[188:191]
    v_exp_f32 v33, v193
    v_mfma_f32_16x16x32_bf16 v[188:191], v[12:15], v[56:59], v[188:191]
    v_exp_f32 v34, v194
    v_mfma_f32_16x16x32_bf16 v[200:203], v[112:115], v[48:51], v[200:203]
    v_exp_f32 v35, v195
    v_mfma_f32_16x16x32_bf16 v[200:203], v[88:91], v[52:55], v[200:203]
    v_exp_f32 v36, v196
    v_mfma_f32_16x16x32_bf16 v[200:203], v[72:75], v[56:59], v[200:203]
    v_exp_f32 v37, v197
    v_mfma_f32_16x16x32_bf16 v[204:207], v[116:119], v[48:51], v[204:207]
    v_exp_f32 v38, v198
    v_mfma_f32_16x16x32_bf16 v[204:207], v[92:95], v[52:55], v[204:207]
    v_exp_f32 v39, v199
    v_mfma_f32_16x16x32_bf16 v[204:207], v[76:79], v[56:59], v[204:207]
    v_fma_f32 v32, v32, s38, s38
    v_fma_f32 v33, v33, s38, s38
    v_mfma_f32_16x16x32_bf16 v[216:219], v[104:107], v[48:51], v[216:219]
    v_fma_f32 v34, v34, s38, s38
    v_fma_f32 v35, v35, s38, s38
    v_mfma_f32_16x16x32_bf16 v[216:219], v[80:83], v[52:55], v[216:219]
    v_fma_f32 v36, v36, s38, s38
    v_fma_f32 v37, v37, s38, s38
    v_mfma_f32_16x16x32_bf16 v[216:219], v[40:43], v[56:59], v[216:219]
    v_fma_f32 v38, v38, s38, s38
    v_fma_f32 v39, v39, s38, s38
    v_mfma_f32_16x16x32_bf16 v[220:223], v[108:111], v[48:51], v[220:223]
    v_rcp_f32 v32, v32
    v_mfma_f32_16x16x32_bf16 v[220:223], v[84:87], v[52:55], v[220:223]
    v_rcp_f32 v33, v33
    v_mfma_f32_16x16x32_bf16 v[220:223], v[44:47], v[56:59], v[220:223]
    v_rcp_f32 v34, v34
    s_waitcnt lgkmcnt(2)
    v_mfma_f32_16x16x32_bf16 v[200:203], v[120:123], v[60:63], v[200:203]
    ds_read_b128 v[48:51], v7 offset:26624
    s_waitcnt lgkmcnt(2)
    v_mfma_f32_16x16x32_bf16 v[200:203], v[96:99], v[64:67], v[200:203]
    ds_read_b128 v[52:55], v6 offset:26624
    s_waitcnt lgkmcnt(2)
    v_mfma_f32_16x16x32_bf16 v[200:203], v[2:5], v[68:71], v[200:203]
    ds_read_b128 v[56:59], v1 offset:26624
    v_mfma_f32_16x16x32_bf16 v[204:207], v[124:127], v[60:63], v[204:207]
    v_rcp_f32 v35, v35
    v_mfma_f32_16x16x32_bf16 v[204:207], v[100:103], v[64:67], v[204:207]
    v_rcp_f32 v36, v36
    v_mfma_f32_16x16x32_bf16 v[204:207], v[12:15], v[68:71], v[204:207]
    v_rcp_f32 v37, v37
    v_mfma_f32_16x16x32_bf16 v[216:219], v[112:115], v[60:63], v[216:219]
    v_rcp_f32 v38, v38
    v_mfma_f32_16x16x32_bf16 v[216:219], v[88:91], v[64:67], v[216:219]
    v_rcp_f32 v39, v39
    v_mfma_f32_16x16x32_bf16 v[216:219], v[72:75], v[68:71], v[216:219]
    v_mul_f32 v192, v192, v32
    v_mul_f32 v193, v193, v33
    v_mfma_f32_16x16x32_bf16 v[220:223], v[116:119], v[60:63], v[220:223]
    v_mul_f32 v194, v194, v34
    v_mul_f32 v195, v195, v35
    v_mfma_f32_16x16x32_bf16 v[220:223], v[92:95], v[64:67], v[220:223]
    v_mul_f32 v196, v196, v36
    v_mul_f32 v197, v197, v37
    v_mfma_f32_16x16x32_bf16 v[220:223], v[76:79], v[68:71], v[220:223]
    v_mul_f32 v198, v198, v38
    v_mul_f32 v199, v199, v39
    v_mfma_f32_16x16x32_bf16 v[232:235], v[104:107], v[60:63], v[232:235]
    v_cvt_pk_bf16_f32 v192, v192, v193
    v_cvt_pk_bf16_f32 v193, v194, v195
    v_mfma_f32_16x16x32_bf16 v[232:235], v[80:83], v[64:67], v[232:235]
    v_cvt_pk_bf16_f32 v194, v196, v197
    v_cvt_pk_bf16_f32 v195, v198, v199
    v_mfma_f32_16x16x32_bf16 v[232:235], v[40:43], v[68:71], v[232:235]
    s_mov_b32 s60, 8192
    v_permlane16_swap_b32 v192, v194
    v_permlane16_swap_b32 v193, v195
    v_mfma_f32_16x16x32_bf16 v[236:239], v[108:111], v[60:63], v[236:239]
    buffer_store_dwordx4 v[192:195], v11, s[16:19], s60 offen sc1
    v_fma_f32 v208, v208, v16, v24
    v_mfma_f32_16x16x32_bf16 v[236:239], v[84:87], v[64:67], v[236:239]
    v_fma_f32 v209, v209, v17, v25
    v_fma_f32 v210, v210, v18, v26
    v_mfma_f32_16x16x32_bf16 v[236:239], v[44:47], v[68:71], v[236:239]
    v_fma_f32 v211, v211, v19, v27
    v_fma_f32 v212, v212, v20, v28
    s_waitcnt lgkmcnt(2)
    v_mfma_f32_16x16x32_bf16 v[216:219], v[120:123], v[48:51], v[216:219]
    ds_read_b128 v[60:63], v7 offset:30720
    v_fma_f32 v213, v213, v21, v29
    s_waitcnt lgkmcnt(2)
    v_mfma_f32_16x16x32_bf16 v[216:219], v[96:99], v[52:55], v[216:219]
    ds_read_b128 v[64:67], v6 offset:30720
    v_fma_f32 v214, v214, v22, v30
    s_waitcnt lgkmcnt(2)
    v_mfma_f32_16x16x32_bf16 v[216:219], v[2:5], v[56:59], v[216:219]
    ds_read_b128 v[68:71], v1 offset:30720
    v_fma_f32 v215, v215, v23, v31
    v_mfma_f32_16x16x32_bf16 v[220:223], v[124:127], v[48:51], v[220:223]
    v_exp_f32 v32, v208
    v_mfma_f32_16x16x32_bf16 v[220:223], v[100:103], v[52:55], v[220:223]
    v_exp_f32 v33, v209
    v_mfma_f32_16x16x32_bf16 v[220:223], v[12:15], v[56:59], v[220:223]
    v_exp_f32 v34, v210
    v_mfma_f32_16x16x32_bf16 v[232:235], v[112:115], v[48:51], v[232:235]
    v_exp_f32 v35, v211
    v_mfma_f32_16x16x32_bf16 v[232:235], v[88:91], v[52:55], v[232:235]
    v_exp_f32 v36, v212
    v_mfma_f32_16x16x32_bf16 v[232:235], v[72:75], v[56:59], v[232:235]
    v_exp_f32 v37, v213
    v_mfma_f32_16x16x32_bf16 v[236:239], v[116:119], v[48:51], v[236:239]
    v_exp_f32 v38, v214
    v_mfma_f32_16x16x32_bf16 v[236:239], v[92:95], v[52:55], v[236:239]
    v_exp_f32 v39, v215
    v_mfma_f32_16x16x32_bf16 v[236:239], v[76:79], v[56:59], v[236:239]
    v_fma_f32 v32, v32, s38, s38
    v_fma_f32 v33, v33, s38, s38
    v_mfma_f32_16x16x32_bf16 v[248:251], v[104:107], v[48:51], v[248:251]
    v_fma_f32 v34, v34, s38, s38
    v_fma_f32 v35, v35, s38, s38
    v_mfma_f32_16x16x32_bf16 v[248:251], v[80:83], v[52:55], v[248:251]
    v_fma_f32 v36, v36, s38, s38
    v_fma_f32 v37, v37, s38, s38
    v_mfma_f32_16x16x32_bf16 v[248:251], v[40:43], v[56:59], v[248:251]
    v_fma_f32 v38, v38, s38, s38
    v_fma_f32 v39, v39, s38, s38
    v_mfma_f32_16x16x32_bf16 v[252:255], v[108:111], v[48:51], v[252:255]
    v_rcp_f32 v32, v32
    v_mfma_f32_16x16x32_bf16 v[252:255], v[84:87], v[52:55], v[252:255]
    v_rcp_f32 v33, v33
    v_mfma_f32_16x16x32_bf16 v[252:255], v[44:47], v[56:59], v[252:255]
    v_rcp_f32 v34, v34
    s_waitcnt lgkmcnt(2)
    v_mfma_f32_16x16x32_bf16 v[232:235], v[120:123], v[60:63], v[232:235]
    v_rcp_f32 v35, v35
    s_waitcnt lgkmcnt(1)
    v_mfma_f32_16x16x32_bf16 v[232:235], v[96:99], v[64:67], v[232:235]
    v_rcp_f32 v36, v36
    s_waitcnt lgkmcnt(0)
    v_mfma_f32_16x16x32_bf16 v[232:235], v[2:5], v[68:71], v[232:235]
    v_rcp_f32 v37, v37
    v_mfma_f32_16x16x32_bf16 v[236:239], v[124:127], v[60:63], v[236:239]
    v_rcp_f32 v38, v38
    v_mfma_f32_16x16x32_bf16 v[236:239], v[100:103], v[64:67], v[236:239]
    v_rcp_f32 v39, v39
    v_mfma_f32_16x16x32_bf16 v[236:239], v[12:15], v[68:71], v[236:239]
    v_mul_f32 v208, v208, v32
    v_mul_f32 v209, v209, v33
    v_mfma_f32_16x16x32_bf16 v[248:251], v[112:115], v[60:63], v[248:251]
    v_mul_f32 v210, v210, v34
    v_mul_f32 v211, v211, v35
    v_mfma_f32_16x16x32_bf16 v[248:251], v[88:91], v[64:67], v[248:251]
    v_mul_f32 v212, v212, v36
    v_mul_f32 v213, v213, v37
    v_mfma_f32_16x16x32_bf16 v[248:251], v[72:75], v[68:71], v[248:251]
    v_mul_f32 v214, v214, v38
    v_mul_f32 v215, v215, v39
    v_mfma_f32_16x16x32_bf16 v[252:255], v[116:119], v[60:63], v[252:255]
    v_cvt_pk_bf16_f32 v208, v208, v209
    v_cvt_pk_bf16_f32 v209, v210, v211
    v_mfma_f32_16x16x32_bf16 v[252:255], v[92:95], v[64:67], v[252:255]
    v_cvt_pk_bf16_f32 v210, v212, v213
    v_cvt_pk_bf16_f32 v211, v214, v215
    v_mfma_f32_16x16x32_bf16 v[252:255], v[76:79], v[68:71], v[252:255]
    s_mov_b32 s61, 10240
    v_permlane16_swap_b32 v208, v210
    v_permlane16_swap_b32 v209, v211
    buffer_store_dwordx4 v[208:211], v11, s[16:19], s61 offen sc1
    v_pk_fma_f32 v[224:225], v[224:225], v[16:17], v[24:25]
    v_pk_fma_f32 v[226:227], v[226:227], v[18:19], v[26:27]
    v_pk_fma_f32 v[228:229], v[228:229], v[20:21], v[28:29]
    v_pk_fma_f32 v[230:231], v[230:231], v[22:23], v[30:31]
    v_exp_f32 v32, v224
    v_exp_f32 v33, v225
    v_exp_f32 v34, v226
    v_exp_f32 v35, v227
    v_exp_f32 v36, v228
    v_exp_f32 v37, v229
    v_exp_f32 v38, v230
    v_exp_f32 v39, v231
    v_pk_fma_f32 v[32:33], v[32:33], s[38:39], s[38:39]
    v_pk_fma_f32 v[34:35], v[34:35], s[38:39], s[38:39]
    v_pk_fma_f32 v[36:37], v[36:37], s[38:39], s[38:39]
    v_pk_fma_f32 v[38:39], v[38:39], s[38:39], s[38:39]
    v_rcp_f32 v32, v32
    v_rcp_f32 v33, v33
    v_rcp_f32 v34, v34
    v_rcp_f32 v35, v35
    v_rcp_f32 v36, v36
    v_rcp_f32 v37, v37
    v_rcp_f32 v38, v38
    v_rcp_f32 v39, v39
    v_pk_mul_f32 v[224:225], v[224:225], v[32:33]
    v_pk_mul_f32 v[226:227], v[226:227], v[34:35]
    v_pk_mul_f32 v[228:229], v[228:229], v[36:37]
    v_pk_mul_f32 v[230:231], v[230:231], v[38:39]
    v_cvt_pk_bf16_f32 v224, v224, v225
    v_cvt_pk_bf16_f32 v225, v226, v227
    v_cvt_pk_bf16_f32 v226, v228, v229
    v_cvt_pk_bf16_f32 v227, v230, v231
    s_mov_b32 s62, 12288
    v_permlane16_swap_b32 v224, v226
    v_permlane16_swap_b32 v225, v227
    buffer_store_dwordx4 v[224:227], v11, s[16:19], s62 offen sc1
    v_pk_fma_f32 v[240:241], v[240:241], v[16:17], v[24:25]
    v_pk_fma_f32 v[242:243], v[242:243], v[18:19], v[26:27]
    v_pk_fma_f32 v[244:245], v[244:245], v[20:21], v[28:29]
    v_pk_fma_f32 v[246:247], v[246:247], v[22:23], v[30:31]
    v_exp_f32 v32, v240
    v_exp_f32 v33, v241
    v_exp_f32 v34, v242
    v_exp_f32 v35, v243
    v_exp_f32 v36, v244
    v_exp_f32 v37, v245
    v_exp_f32 v38, v246
    v_exp_f32 v39, v247
    v_pk_fma_f32 v[32:33], v[32:33], s[38:39], s[38:39]
    v_pk_fma_f32 v[34:35], v[34:35], s[38:39], s[38:39]
    v_pk_fma_f32 v[36:37], v[36:37], s[38:39], s[38:39]
    v_pk_fma_f32 v[38:39], v[38:39], s[38:39], s[38:39]
    v_rcp_f32 v32, v32
    v_rcp_f32 v33, v33
    v_rcp_f32 v34, v34
    v_rcp_f32 v35, v35
    v_rcp_f32 v36, v36
    v_rcp_f32 v37, v37
    v_rcp_f32 v38, v38
    v_rcp_f32 v39, v39
    v_pk_mul_f32 v[240:241], v[240:241], v[32:33]
    v_pk_mul_f32 v[242:243], v[242:243], v[34:35]
    v_pk_mul_f32 v[244:245], v[244:245], v[36:37]
    v_pk_mul_f32 v[246:247], v[246:247], v[38:39]
    v_cvt_pk_bf16_f32 v240, v240, v241
    v_cvt_pk_bf16_f32 v241, v242, v243
    v_cvt_pk_bf16_f32 v242, v244, v245
    v_cvt_pk_bf16_f32 v243, v246, v247
    s_mov_b32 s63, 14336
    v_permlane16_swap_b32 v240, v242
    v_permlane16_swap_b32 v241, v243
    buffer_store_dwordx4 v[240:243], v11, s[16:19], s63 offen sc1
    v_pk_fma_f32 v[136:137], v[136:137], v[16:17], v[24:25]
    v_pk_fma_f32 v[138:139], v[138:139], v[18:19], v[26:27]
    v_pk_fma_f32 v[140:141], v[140:141], v[20:21], v[28:29]
    v_pk_fma_f32 v[142:143], v[142:143], v[22:23], v[30:31]
    v_exp_f32 v32, v136
    v_exp_f32 v33, v137
    v_exp_f32 v34, v138
    v_exp_f32 v35, v139
    v_exp_f32 v36, v140
    v_exp_f32 v37, v141
    v_exp_f32 v38, v142
    v_exp_f32 v39, v143
    v_pk_fma_f32 v[32:33], v[32:33], s[38:39], s[38:39]
    v_pk_fma_f32 v[34:35], v[34:35], s[38:39], s[38:39]
    v_pk_fma_f32 v[36:37], v[36:37], s[38:39], s[38:39]
    v_pk_fma_f32 v[38:39], v[38:39], s[38:39], s[38:39]
    v_rcp_f32 v32, v32
    v_rcp_f32 v33, v33
    v_rcp_f32 v34, v34
    v_rcp_f32 v35, v35
    v_rcp_f32 v36, v36
    v_rcp_f32 v37, v37
    v_rcp_f32 v38, v38
    v_rcp_f32 v39, v39
    v_pk_mul_f32 v[136:137], v[136:137], v[32:33]
    v_pk_mul_f32 v[138:139], v[138:139], v[34:35]
    v_pk_mul_f32 v[140:141], v[140:141], v[36:37]
    v_pk_mul_f32 v[142:143], v[142:143], v[38:39]
    v_cvt_pk_bf16_f32 v136, v136, v137
    v_cvt_pk_bf16_f32 v137, v138, v139
    v_cvt_pk_bf16_f32 v138, v140, v141
    v_cvt_pk_bf16_f32 v139, v142, v143
    s_mov_b32 s60, 262144
    v_permlane16_swap_b32 v136, v138
    v_permlane16_swap_b32 v137, v139
    buffer_store_dwordx4 v[136:139], v11, s[16:19], s60 offen sc1
    v_pk_fma_f32 v[152:153], v[152:153], v[16:17], v[24:25]
    v_pk_fma_f32 v[154:155], v[154:155], v[18:19], v[26:27]
    v_pk_fma_f32 v[156:157], v[156:157], v[20:21], v[28:29]
    v_pk_fma_f32 v[158:159], v[158:159], v[22:23], v[30:31]
    v_exp_f32 v32, v152
    v_exp_f32 v33, v153
    v_exp_f32 v34, v154
    v_exp_f32 v35, v155
    v_exp_f32 v36, v156
    v_exp_f32 v37, v157
    v_exp_f32 v38, v158
    v_exp_f32 v39, v159
    v_pk_fma_f32 v[32:33], v[32:33], s[38:39], s[38:39]
    v_pk_fma_f32 v[34:35], v[34:35], s[38:39], s[38:39]
    v_pk_fma_f32 v[36:37], v[36:37], s[38:39], s[38:39]
    v_pk_fma_f32 v[38:39], v[38:39], s[38:39], s[38:39]
    v_rcp_f32 v32, v32
    v_rcp_f32 v33, v33
    v_rcp_f32 v34, v34
    v_rcp_f32 v35, v35
    v_rcp_f32 v36, v36
    v_rcp_f32 v37, v37
    v_rcp_f32 v38, v38
    v_rcp_f32 v39, v39
    v_pk_mul_f32 v[152:153], v[152:153], v[32:33]
    v_pk_mul_f32 v[154:155], v[154:155], v[34:35]
    v_pk_mul_f32 v[156:157], v[156:157], v[36:37]
    v_pk_mul_f32 v[158:159], v[158:159], v[38:39]
    v_cvt_pk_bf16_f32 v152, v152, v153
    v_cvt_pk_bf16_f32 v153, v154, v155
    v_cvt_pk_bf16_f32 v154, v156, v157
    v_cvt_pk_bf16_f32 v155, v158, v159
    s_mov_b32 s61, 264192
    v_permlane16_swap_b32 v152, v154
    v_permlane16_swap_b32 v153, v155
    buffer_store_dwordx4 v[152:155], v11, s[16:19], s61 offen sc1
    v_pk_fma_f32 v[168:169], v[168:169], v[16:17], v[24:25]
    v_pk_fma_f32 v[170:171], v[170:171], v[18:19], v[26:27]
    v_pk_fma_f32 v[172:173], v[172:173], v[20:21], v[28:29]
    v_pk_fma_f32 v[174:175], v[174:175], v[22:23], v[30:31]
    v_exp_f32 v32, v168
    v_exp_f32 v33, v169
    v_exp_f32 v34, v170
    v_exp_f32 v35, v171
    v_exp_f32 v36, v172
    v_exp_f32 v37, v173
    v_exp_f32 v38, v174
    v_exp_f32 v39, v175
    v_pk_fma_f32 v[32:33], v[32:33], s[38:39], s[38:39]
    v_pk_fma_f32 v[34:35], v[34:35], s[38:39], s[38:39]
    v_pk_fma_f32 v[36:37], v[36:37], s[38:39], s[38:39]
    v_pk_fma_f32 v[38:39], v[38:39], s[38:39], s[38:39]
    v_rcp_f32 v32, v32
    v_rcp_f32 v33, v33
    v_rcp_f32 v34, v34
    v_rcp_f32 v35, v35
    v_rcp_f32 v36, v36
    v_rcp_f32 v37, v37
    v_rcp_f32 v38, v38
    v_rcp_f32 v39, v39
    v_pk_mul_f32 v[168:169], v[168:169], v[32:33]
    v_pk_mul_f32 v[170:171], v[170:171], v[34:35]
    v_pk_mul_f32 v[172:173], v[172:173], v[36:37]
    v_pk_mul_f32 v[174:175], v[174:175], v[38:39]
    v_cvt_pk_bf16_f32 v168, v168, v169
    v_cvt_pk_bf16_f32 v169, v170, v171
    v_cvt_pk_bf16_f32 v170, v172, v173
    v_cvt_pk_bf16_f32 v171, v174, v175
    s_mov_b32 s62, 266240
    v_permlane16_swap_b32 v168, v170
    v_permlane16_swap_b32 v169, v171
    buffer_store_dwordx4 v[168:171], v11, s[16:19], s62 offen sc1
    v_pk_fma_f32 v[184:185], v[184:185], v[16:17], v[24:25]
    v_pk_fma_f32 v[186:187], v[186:187], v[18:19], v[26:27]
    v_pk_fma_f32 v[188:189], v[188:189], v[20:21], v[28:29]
    v_pk_fma_f32 v[190:191], v[190:191], v[22:23], v[30:31]
    v_exp_f32 v32, v184
    v_exp_f32 v33, v185
    v_exp_f32 v34, v186
    v_exp_f32 v35, v187
    v_exp_f32 v36, v188
    v_exp_f32 v37, v189
    v_exp_f32 v38, v190
    v_exp_f32 v39, v191
    v_pk_fma_f32 v[32:33], v[32:33], s[38:39], s[38:39]
    v_pk_fma_f32 v[34:35], v[34:35], s[38:39], s[38:39]
    v_pk_fma_f32 v[36:37], v[36:37], s[38:39], s[38:39]
    v_pk_fma_f32 v[38:39], v[38:39], s[38:39], s[38:39]
    v_rcp_f32 v32, v32
    v_rcp_f32 v33, v33
    v_rcp_f32 v34, v34
    v_rcp_f32 v35, v35
    v_rcp_f32 v36, v36
    v_rcp_f32 v37, v37
    v_rcp_f32 v38, v38
    v_rcp_f32 v39, v39
    v_pk_mul_f32 v[184:185], v[184:185], v[32:33]
    v_pk_mul_f32 v[186:187], v[186:187], v[34:35]
    v_pk_mul_f32 v[188:189], v[188:189], v[36:37]
    v_pk_mul_f32 v[190:191], v[190:191], v[38:39]
    v_cvt_pk_bf16_f32 v184, v184, v185
    v_cvt_pk_bf16_f32 v185, v186, v187
    v_cvt_pk_bf16_f32 v186, v188, v189
    v_cvt_pk_bf16_f32 v187, v190, v191
    s_mov_b32 s63, 268288
    v_permlane16_swap_b32 v184, v186
    v_permlane16_swap_b32 v185, v187
    buffer_store_dwordx4 v[184:187], v11, s[16:19], s63 offen sc1
    v_pk_fma_f32 v[200:201], v[200:201], v[16:17], v[24:25]
    v_pk_fma_f32 v[202:203], v[202:203], v[18:19], v[26:27]
    v_pk_fma_f32 v[204:205], v[204:205], v[20:21], v[28:29]
    v_pk_fma_f32 v[206:207], v[206:207], v[22:23], v[30:31]
    v_exp_f32 v32, v200
    v_exp_f32 v33, v201
    v_exp_f32 v34, v202
    v_exp_f32 v35, v203
    v_exp_f32 v36, v204
    v_exp_f32 v37, v205
    v_exp_f32 v38, v206
    v_exp_f32 v39, v207
    v_pk_fma_f32 v[32:33], v[32:33], s[38:39], s[38:39]
    v_pk_fma_f32 v[34:35], v[34:35], s[38:39], s[38:39]
    v_pk_fma_f32 v[36:37], v[36:37], s[38:39], s[38:39]
    v_pk_fma_f32 v[38:39], v[38:39], s[38:39], s[38:39]
    v_rcp_f32 v32, v32
    v_rcp_f32 v33, v33
    v_rcp_f32 v34, v34
    v_rcp_f32 v35, v35
    v_rcp_f32 v36, v36
    v_rcp_f32 v37, v37
    v_rcp_f32 v38, v38
    v_rcp_f32 v39, v39
    v_pk_mul_f32 v[200:201], v[200:201], v[32:33]
    v_pk_mul_f32 v[202:203], v[202:203], v[34:35]
    v_pk_mul_f32 v[204:205], v[204:205], v[36:37]
    v_pk_mul_f32 v[206:207], v[206:207], v[38:39]
    v_cvt_pk_bf16_f32 v200, v200, v201
    v_cvt_pk_bf16_f32 v201, v202, v203
    v_cvt_pk_bf16_f32 v202, v204, v205
    v_cvt_pk_bf16_f32 v203, v206, v207
    s_mov_b32 s60, 270336
    v_permlane16_swap_b32 v200, v202
    v_permlane16_swap_b32 v201, v203
    buffer_store_dwordx4 v[200:203], v11, s[16:19], s60 offen sc1
    v_pk_fma_f32 v[216:217], v[216:217], v[16:17], v[24:25]
    v_pk_fma_f32 v[218:219], v[218:219], v[18:19], v[26:27]
    v_pk_fma_f32 v[220:221], v[220:221], v[20:21], v[28:29]
    v_pk_fma_f32 v[222:223], v[222:223], v[22:23], v[30:31]
    v_exp_f32 v32, v216
    v_exp_f32 v33, v217
    v_exp_f32 v34, v218
    v_exp_f32 v35, v219
    v_exp_f32 v36, v220
    v_exp_f32 v37, v221
    v_exp_f32 v38, v222
    v_exp_f32 v39, v223
    v_pk_fma_f32 v[32:33], v[32:33], s[38:39], s[38:39]
    v_pk_fma_f32 v[34:35], v[34:35], s[38:39], s[38:39]
    v_pk_fma_f32 v[36:37], v[36:37], s[38:39], s[38:39]
    v_pk_fma_f32 v[38:39], v[38:39], s[38:39], s[38:39]
    v_rcp_f32 v32, v32
    v_rcp_f32 v33, v33
    v_rcp_f32 v34, v34
    v_rcp_f32 v35, v35
    v_rcp_f32 v36, v36
    v_rcp_f32 v37, v37
    v_rcp_f32 v38, v38
    v_rcp_f32 v39, v39
    v_pk_mul_f32 v[216:217], v[216:217], v[32:33]
    v_pk_mul_f32 v[218:219], v[218:219], v[34:35]
    v_pk_mul_f32 v[220:221], v[220:221], v[36:37]
    v_pk_mul_f32 v[222:223], v[222:223], v[38:39]
    v_cvt_pk_bf16_f32 v216, v216, v217
    v_cvt_pk_bf16_f32 v217, v218, v219
    v_cvt_pk_bf16_f32 v218, v220, v221
    v_cvt_pk_bf16_f32 v219, v222, v223
    s_mov_b32 s61, 272384
    v_permlane16_swap_b32 v216, v218
    v_permlane16_swap_b32 v217, v219
    buffer_store_dwordx4 v[216:219], v11, s[16:19], s61 offen sc1
    v_pk_fma_f32 v[232:233], v[232:233], v[16:17], v[24:25]
    v_pk_fma_f32 v[234:235], v[234:235], v[18:19], v[26:27]
    v_pk_fma_f32 v[236:237], v[236:237], v[20:21], v[28:29]
    v_pk_fma_f32 v[238:239], v[238:239], v[22:23], v[30:31]
    v_exp_f32 v32, v232
    v_exp_f32 v33, v233
    v_exp_f32 v34, v234
    v_exp_f32 v35, v235
    v_exp_f32 v36, v236
    v_exp_f32 v37, v237
    v_exp_f32 v38, v238
    v_exp_f32 v39, v239
    v_pk_fma_f32 v[32:33], v[32:33], s[38:39], s[38:39]
    v_pk_fma_f32 v[34:35], v[34:35], s[38:39], s[38:39]
    v_pk_fma_f32 v[36:37], v[36:37], s[38:39], s[38:39]
    v_pk_fma_f32 v[38:39], v[38:39], s[38:39], s[38:39]
    v_rcp_f32 v32, v32
    v_rcp_f32 v33, v33
    v_rcp_f32 v34, v34
    v_rcp_f32 v35, v35
    v_rcp_f32 v36, v36
    v_rcp_f32 v37, v37
    v_rcp_f32 v38, v38
    v_rcp_f32 v39, v39
    v_pk_mul_f32 v[232:233], v[232:233], v[32:33]
    v_pk_mul_f32 v[234:235], v[234:235], v[34:35]
    v_pk_mul_f32 v[236:237], v[236:237], v[36:37]
    v_pk_mul_f32 v[238:239], v[238:239], v[38:39]
    v_cvt_pk_bf16_f32 v232, v232, v233
    v_cvt_pk_bf16_f32 v233, v234, v235
    v_cvt_pk_bf16_f32 v234, v236, v237
    v_cvt_pk_bf16_f32 v235, v238, v239
    s_mov_b32 s62, 274432
    v_permlane16_swap_b32 v232, v234
    v_permlane16_swap_b32 v233, v235
    buffer_store_dwordx4 v[232:235], v11, s[16:19], s62 offen sc1
    v_pk_fma_f32 v[248:249], v[248:249], v[16:17], v[24:25]
    v_pk_fma_f32 v[250:251], v[250:251], v[18:19], v[26:27]
    v_pk_fma_f32 v[252:253], v[252:253], v[20:21], v[28:29]
    v_pk_fma_f32 v[254:255], v[254:255], v[22:23], v[30:31]
    v_exp_f32 v32, v248
    v_exp_f32 v33, v249
    v_exp_f32 v34, v250
    v_exp_f32 v35, v251
    v_exp_f32 v36, v252
    v_exp_f32 v37, v253
    v_exp_f32 v38, v254
    v_exp_f32 v39, v255
    v_pk_fma_f32 v[32:33], v[32:33], s[38:39], s[38:39]
    v_pk_fma_f32 v[34:35], v[34:35], s[38:39], s[38:39]
    v_pk_fma_f32 v[36:37], v[36:37], s[38:39], s[38:39]
    v_pk_fma_f32 v[38:39], v[38:39], s[38:39], s[38:39]
    v_rcp_f32 v32, v32
    v_rcp_f32 v33, v33
    v_rcp_f32 v34, v34
    v_rcp_f32 v35, v35
    v_rcp_f32 v36, v36
    v_rcp_f32 v37, v37
    v_rcp_f32 v38, v38
    v_rcp_f32 v39, v39
    v_pk_mul_f32 v[248:249], v[248:249], v[32:33]
    v_pk_mul_f32 v[250:251], v[250:251], v[34:35]
    v_pk_mul_f32 v[252:253], v[252:253], v[36:37]
    v_pk_mul_f32 v[254:255], v[254:255], v[38:39]
    v_cvt_pk_bf16_f32 v248, v248, v249
    v_cvt_pk_bf16_f32 v249, v250, v251
    v_cvt_pk_bf16_f32 v250, v252, v253
    v_cvt_pk_bf16_f32 v251, v254, v255
    s_mov_b32 s63, 276480
    v_permlane16_swap_b32 v248, v250
    v_permlane16_swap_b32 v249, v251
    buffer_store_dwordx4 v[248:251], v11, s[16:19], s63 offen sc1
L_end:
    s_endpgm
.section .rodata,"a"
.p2align 6
.amdhsa_kernel standalone__batchnorm__sampling_kernel
  .amdhsa_next_free_vgpr 256
  .amdhsa_next_free_sgpr 72
  .amdhsa_accum_offset 256
  .amdhsa_group_segment_fixed_size 0
  .amdhsa_kernarg_size 72
  .amdhsa_user_sgpr_count 2
  .amdhsa_user_sgpr_kernarg_segment_ptr 1
  .amdhsa_system_sgpr_workgroup_id_x 1
.end_amdhsa_kernel
```
